```python
import torch

def _softmax(x, axis=-1):
    return torch.softmax(x, dim=axis)

def _gelu(x):
    return torch.nn.functional.gelu(x, approximate='tanh')

def _silu(x):
    return torch.nn.functional.silu(x)

def _sigmoid(x):
    return torch.sigmoid(x)

def _layernorm(x, axis=-1, eps=1e-05):
    m = x.mean(dim=axis, keepdim=True)
    v = x.var(dim=axis, keepdim=True, unbiased=False)
    return (x - m) / torch.sqrt(v + eps)

def _scatter_add(tgt, idx, src, axis=0):
    return tgt.clone().index_add_(axis, idx, src)

def _segment_sum(src, seg, n):
    out = torch.zeros((n,) + src.shape[1:], dtype=src.dtype)
    return out.index_add_(0, seg, src)

def _pad(x, pw):
    flat = tuple((v for pair in reversed(pw) for v in pair))
    return torch.nn.functional.pad(x, flat)
kernel_name = 'adaLN_cond__sliding_block_cached__dense_activation_silu__decode'

def setup_inputs():

    _w = lambda a: (lambda t: t.to(torch.bfloat16) if t.is_floating_point() else t)(torch.as_tensor(a))

    def _A_setup():
        B, Sq, D = (2, 1, 512)
        Hq, Hkv, Sk, Dh = (32, 8, 32768, 128)
        assert Hq % Hkv == 0, (Hq, Hkv)
        return {'x': _w((lambda *s: torch.randn(*s, dtype=torch.bfloat16) * 0.1)(B, Sq, D)), 'k_cache': _w((lambda *s: torch.randn(*s, dtype=torch.bfloat16) * 0.8)(B, Hkv, Sk, Dh)), 'v_cache': _w((lambda *s: torch.randn(*s, dtype=torch.bfloat16) * 3.2)(B, Hkv, Sk, Dh)), 'wq': _w((lambda *s: torch.randn(*s, dtype=torch.bfloat16) * 0.8)(D, Hq * Dh) * D ** (-0.5)), 'wo': _w((lambda *s: torch.randn(*s, dtype=torch.bfloat16) * 3.2)(Hq * Dh, D) * (Hq * Dh) ** (-0.5))}
    _A_in = _A_setup()

    def _B_setup():
        B, S, D, F = (2, 1, 512, 1792)
        return {'x': _w((lambda *s: torch.randn(*s, dtype=torch.bfloat16) * 0.1)(B, S, D)), 'w1': _w((lambda *s: torch.randn(*s, dtype=torch.bfloat16) * 3.2)(D, F) * D ** (-0.5)), 'w2': _w((lambda *s: torch.randn(*s, dtype=torch.bfloat16) * 3.2)(F, D) * F ** (-0.5))}
    _B_in = _B_setup()
    return {'A_x': _A_in['x'], 'A_k_cache': _A_in['k_cache'], 'A_v_cache': _A_in['v_cache'], 'A_wq': _A_in['wq'], 'A_wo': _A_in['wo'], 'B_x': _B_in['x'], 'B_w1': _B_in['w1'], 'B_w2': _B_in['w2'], 'c': _w((lambda *s: torch.randn(*s, dtype=torch.bfloat16) * 0.2)(2, 512) * 8.0), 'w_mod': _w((lambda *s: torch.randn(*s, dtype=torch.bfloat16) * 0.2)(512, 6 * 512) * 512 ** (-0.5) * 8.0)}

def reference(A_x, A_k_cache, A_v_cache, A_wq, A_wo, B_x, B_w1, B_w2, c, w_mod):

    def _A_ref(x, k_cache, v_cache, wq, wo):
        B, Sq, D = x.shape
        Hq, Dh = (32, 128)
        Hkv, Sk = (k_cache.shape[1], k_cache.shape[2])
        W = min(4096, max(256, Sk // 4))
        rep = Hq // Hkv
        q = (lambda x, *d: x.permute(*d))((x @ wq).reshape(B, Sq, Hq, Dh), 0, 2, 1, 3)
        k = (lambda x, n, axis: torch.repeat_interleave(x, n, dim=axis))(k_cache[:, :, Sk - W:, :], rep, axis=1)
        v = (lambda x, n, axis: torch.repeat_interleave(x, n, dim=axis))(v_cache[:, :, Sk - W:, :], rep, axis=1)
        scores = torch.einsum('bhqd,bhkd->bhqk', q, k) * Dh ** (-0.5)
        p = _softmax(scores, axis=-1)
        o = torch.einsum('bhqk,bhkd->bhqd', p, v)
        return (lambda x, *d: x.permute(*d))(o, 0, 2, 1, 3).reshape(B, Sq, Hq * Dh) @ wo

    def _B_ref(x, w1, w2):
        h = torch.einsum('bsd,df->bsf', x, w1)
        h = _silu(h)
        out = torch.einsum('bsf,fd->bsd', h, w2)
        return out
    x = A_x
    mod = (_silu(c) @ w_mod).reshape(c.shape[0], 6, 1, -1)
    sa, ca, ga, sb, cb, gb = (mod[:, 0].clone(), mod[:, 1].clone(), mod[:, 2].clone(), mod[:, 3].clone(), mod[:, 4].clone(), mod[:, 5].clone())
    h = _layernorm(x, axis=-1) * (1 + ca) + sa
    x = x + ga * _A_ref(h, A_k_cache, A_v_cache, A_wq, A_wo)
    h = _layernorm(x, axis=-1) * (1 + cb) + sb
    x = x + gb * _B_ref(h, B_w1, B_w2)
    return x
```

```asm
; @launch grid=(256,1,1) block=(384,1,1) lds=163840
.amdgcn_target "amdgcn-amd-amdhsa--gfx950"
.text
.globl adaLN_cond__sliding_block_cached__dense_activation_silu__decode_kernel
.p2align 8
.type adaLN_cond__sliding_block_cached__dense_activation_silu__decode_kernel,@function
adaLN_cond__sliding_block_cached__dense_activation_silu__decode_kernel:
    s_load_dwordx2 s[20:21], s[0:1], 8
    s_load_dwordx2 s[8:9], s[0:1], 72
    s_cmp_ge_u32 s2, 256
    s_cbranch_scc1 L_end
    v_lshrrev_b32 v1, 6, v0
    s_and_b32 s36, s2, 7
    s_lshr_b32 s37, s2, 3
    v_readfirstlane_b32 s3, v1
    v_and_b32 v1, 63, v0
    v_lshrrev_b32 v2, 4, v1
    v_and_b32 v3, 15, v1
    s_lshr_b32 s45, s37, 4
    s_and_b32 s46, s37, 15
    s_cmp_lg_u32 s3, 0
    s_cbranch_scc1 L_notloader

    s_bfe_u32 s34, s2, 0x40002
    s_and_b32 s33, s2, 3
    v_xor_b32 v26, v2, v3
    v_lshlrev_b32 v26, 4, v26
    v_lshl_or_b32 v12, v2, 8, v26
    v_xor_b32 v13, 64, v12
    v_xor_b32 v14, 128, v12
    v_xor_b32 v15, 192, v12
    v_and_b32 v26, 7, v1
    v_lshlrev_b32 v27, 1, v2
    v_xor_b32 v26, v26, v27
    v_lshlrev_b32 v26, 4, v26
    v_lshrrev_b32 v27, 3, v1
    v_mul_u32_u24 v4, 6144, v27
    v_add_u32 v4, v4, v26
    v_add_u32 v5, 48128, v4
    v_add_u32 v6, 96256, v4
    v_add_u32 v7, 144384, v4
    s_mul_i32 s39, s33, 786432
    s_lshl_b32 s59, s34, 7
    s_add_u32 s39, s39, s59
    s_lshl_b32 s38, s45, 26
    s_lshl_b32 s59, s36, 23
    s_add_u32 s38, s38, s59
    s_lshl_b32 s59, s46, 16
    s_add_u32 s38, s38, s59
    s_add_u32 s38, s38, 7340032
    s_mul_i32 s41, s37, 1
    s_mul_i32 s59, s36, 2
    s_add_u32 s41, s41, s59
    s_and_b32 s41, s41, 15
    s_lshl_b32 s41, s41, 12
    s_mov_b32 s10, 3145728
    s_mov_b32 s11, 0x20000
    s_mov_b32 s22, 65536
    s_mov_b32 s23, 0x20000
    s_cmp_ge_u32 s37, 24
    s_cselect_b64 vcc, -1, 0
    s_cselect_b32 s40, s39, s41
    s_cselect_b32 m0, 114688, 0
    s_mov_b32 s57, 65536
    s_cselect_b32 s57, 196608, s57
    s_cselect_b32 s58, -1, 0xffff
    s_cselect_b32 s6, s10, s22
    s_cselect_b32 s42, 0, 4
    s_lshr_b32 s57, s57, s42
    v_cndmask_b32 v38, v12, v4, vcc
    v_cndmask_b32 v39, v13, v5, vcc
    v_cndmask_b32 v40, v14, v6, vcc
    v_cndmask_b32 v41, v15, v7, vcc
    s_mov_b32 s7, 0x20000
    s_waitcnt lgkmcnt(0)
    s_add_u32 s20, s20, s38
    s_addc_u32 s21, s21, 0
    s_cmp_ge_u32 s37, 24
    s_cselect_b64 s[4:5], s[8:9], s[20:21]
    buffer_load_dwordx4 v38, s[4:7], s40 offen offset:0 nt lds
    buffer_load_dwordx4 v39, s[4:7], s40 offen offset:1024 nt lds
    buffer_load_dwordx4 v40, s[4:7], s40 offen offset:2048 nt lds
    buffer_load_dwordx4 v41, s[4:7], s40 offen offset:3072 nt lds
    s_add_u32 s40, s40, s57
    s_and_b32 s40, s40, s58
    s_add_u32 m0, m0, 4096
    s_nop 0
    buffer_load_dwordx4 v38, s[4:7], s40 offen offset:0 nt lds
    buffer_load_dwordx4 v39, s[4:7], s40 offen offset:1024 nt lds
    buffer_load_dwordx4 v40, s[4:7], s40 offen offset:2048 nt lds
    buffer_load_dwordx4 v41, s[4:7], s40 offen offset:3072 nt lds
    s_add_u32 s40, s40, s57
    s_and_b32 s40, s40, s58
    s_add_u32 m0, m0, 4096
    s_nop 0
    buffer_load_dwordx4 v38, s[4:7], s40 offen offset:0 nt lds
    buffer_load_dwordx4 v39, s[4:7], s40 offen offset:1024 nt lds
    buffer_load_dwordx4 v40, s[4:7], s40 offen offset:2048 nt lds
    buffer_load_dwordx4 v41, s[4:7], s40 offen offset:3072 nt lds
    s_add_u32 s40, s40, s57
    s_and_b32 s40, s40, s58
    s_add_u32 m0, m0, 4096
    s_nop 0
    buffer_load_dwordx4 v38, s[4:7], s40 offen offset:0 nt lds
    buffer_load_dwordx4 v39, s[4:7], s40 offen offset:1024 nt lds
    buffer_load_dwordx4 v40, s[4:7], s40 offen offset:2048 nt lds
    buffer_load_dwordx4 v41, s[4:7], s40 offen offset:3072 nt lds
    s_add_u32 s40, s40, s57
    s_and_b32 s40, s40, s58
    s_setprio 3
    s_load_dwordx2 s[12:13], s[0:1], 24
    s_load_dwordx2 s[24:25], s[0:1], 16
    v_lshlrev_b32 v28, 4, v1
    v_add_u32 v28, 131072, v28
    v_subrev_u32 v29, 4, v1
    v_cmp_gt_u32 vcc, 8, v29
    s_nop 1
    v_cndmask_b32 v32, 0, -1, vcc
    v_mov_b32 v33, v32
    v_mov_b32 v34, v32
    v_mov_b32 v35, v32
    s_mov_b64 exec, 0xffff
    ds_write_b128 v28, v[32:35]
    s_mov_b64 exec, -1
    v_lshl_or_b32 v8, v27, 13, v26
    s_lshr_b32 s35, s37, 3
    s_cmp_ge_u32 s37, 24
    s_cselect_b32 s41, s41, s40
    s_waitcnt lgkmcnt(0)
    s_barrier

    v_add_u32 v9, 64512, v8
    v_add_u32 v10, 129024, v8
    v_add_u32 v11, 193536, v8
    s_mov_b32 s14, 4194304
    s_mov_b32 s15, 0x20000
    s_and_b32 s42, s37, 7
    s_lshl_b32 s40, s35, 20
    s_lshl_b32 s59, s36, 10
    s_add_u32 s40, s40, s59
    s_lshl_b32 s59, s42, 7
    s_add_u32 s40, s40, s59
    v_mov_b32 v28, 131072
    v_mov_b32 v29, 1
    s_lshr_b32 s42, s2, 2
    s_add_u32 s42, s42, 16
    s_mul_i32 s32, s33, 786432
    s_lshl_b32 s59, s42, 7
    s_add_u32 s32, s32, s59
    s_cmp_lt_u32 s37, 16
    s_cselect_b32 s56, 32, 48
    s_load_dwordx2 s[4:5], s[0:1], s56
    s_load_dwordx2 s[28:29], s[0:1], 56
    s_add_u32 s24, s24, s38
    s_addc_u32 s25, s25, 0
    s_mov_b32 s26, 65536
    s_mov_b32 s27, 0x20000
    v_lshlrev_b32 v26, 1, v2
    v_xor_b32 v26, v26, v3
    v_lshlrev_b32 v26, 4, v26
    v_lshl_or_b32 v16, v2, 8, v26
    v_xor_b32 v17, 128, v16
    v_lshl_or_b32 v18, v2, 10, v26
    v_xor_b32 v26, 128, v18
    v_add_u32 v19, 3072, v26
    v_add_u32 v20, 6144, v18
    v_add_u32 v21, 9216, v26
    s_cmp_ge_u32 s37, 24
    s_cbranch_scc1 L_l_crit
    s_cmp_lt_u32 s37, 16
    s_cbranch_scc1 L_l_light
    s_mov_b32 m0, 147456
    s_waitcnt vmcnt(15)
    buffer_load_dwordx4 v8, s[12:15], s40 offen offset:0 nt lds
    s_waitcnt vmcnt(15)
    buffer_load_dwordx4 v9, s[12:15], s40 offen offset:1024 nt lds
    s_waitcnt vmcnt(15)
    buffer_load_dwordx4 v10, s[12:15], s40 offen offset:2048 nt lds
    s_waitcnt vmcnt(15)
    buffer_load_dwordx4 v11, s[12:15], s40 offen offset:3072 nt lds
    s_add_u32 s40, s40, 262144
    s_mov_b32 m0, 151552
    s_waitcnt vmcnt(15)
    buffer_load_dwordx4 v8, s[12:15], s40 offen offset:0 nt lds
    s_waitcnt vmcnt(15)
    buffer_load_dwordx4 v9, s[12:15], s40 offen offset:1024 nt lds
    s_waitcnt vmcnt(15)
    buffer_load_dwordx4 v10, s[12:15], s40 offen offset:2048 nt lds
    s_waitcnt vmcnt(15)
    buffer_load_dwordx4 v11, s[12:15], s40 offen offset:3072 nt lds
    s_add_u32 s40, s40, 262144
    s_mov_b32 m0, 155648
    s_waitcnt vmcnt(15)
    buffer_load_dwordx4 v8, s[12:15], s40 offen offset:0 nt lds
    s_waitcnt vmcnt(15)
    buffer_load_dwordx4 v9, s[12:15], s40 offen offset:1024 nt lds
    s_waitcnt vmcnt(15)
    buffer_load_dwordx4 v10, s[12:15], s40 offen offset:2048 nt lds
    s_waitcnt vmcnt(15)
    buffer_load_dwordx4 v11, s[12:15], s40 offen offset:3072 nt lds
    s_add_u32 s40, s40, 262144
    s_mov_b32 m0, 159744
    s_waitcnt vmcnt(15)
    buffer_load_dwordx4 v8, s[12:15], s40 offen offset:0 nt lds
    s_waitcnt vmcnt(15)
    buffer_load_dwordx4 v9, s[12:15], s40 offen offset:1024 nt lds
    s_waitcnt vmcnt(15)
    buffer_load_dwordx4 v10, s[12:15], s40 offen offset:2048 nt lds
    s_waitcnt vmcnt(15)
    buffer_load_dwordx4 v11, s[12:15], s40 offen offset:3072 nt lds
    s_mov_b32 m0, 16384
    s_waitcnt vmcnt(15)
    buffer_load_dwordx4 v12, s[20:23], s41 offen offset:0 nt lds
    s_waitcnt vmcnt(15)
    buffer_load_dwordx4 v13, s[20:23], s41 offen offset:1024 nt lds
    s_waitcnt vmcnt(15)
    buffer_load_dwordx4 v14, s[20:23], s41 offen offset:2048 nt lds
    s_waitcnt vmcnt(15)
    buffer_load_dwordx4 v15, s[20:23], s41 offen offset:3072 nt lds
    s_add_u32 s41, s41, 4096
    s_and_b32 s41, s41, 0xffff
    s_mov_b32 m0, 20480
    s_waitcnt vmcnt(15)
    buffer_load_dwordx4 v12, s[20:23], s41 offen offset:0 nt lds
    s_waitcnt vmcnt(15)
    buffer_load_dwordx4 v13, s[20:23], s41 offen offset:1024 nt lds
    s_waitcnt vmcnt(15)
    buffer_load_dwordx4 v14, s[20:23], s41 offen offset:2048 nt lds
    s_waitcnt vmcnt(15)
    buffer_load_dwordx4 v15, s[20:23], s41 offen offset:3072 nt lds
    s_add_u32 s41, s41, 4096
    s_and_b32 s41, s41, 0xffff
    s_mov_b32 m0, 24576
    s_waitcnt vmcnt(15)
    buffer_load_dwordx4 v12, s[20:23], s41 offen offset:0 nt lds
    s_waitcnt vmcnt(15)
    buffer_load_dwordx4 v13, s[20:23], s41 offen offset:1024 nt lds
    s_waitcnt vmcnt(15)
    buffer_load_dwordx4 v14, s[20:23], s41 offen offset:2048 nt lds
    s_waitcnt vmcnt(15)
    buffer_load_dwordx4 v15, s[20:23], s41 offen offset:3072 nt lds
    s_add_u32 s41, s41, 4096
    s_and_b32 s41, s41, 0xffff
    s_mov_b32 m0, 28672
    s_waitcnt vmcnt(15)
    buffer_load_dwordx4 v12, s[20:23], s41 offen offset:0 nt lds
    s_waitcnt vmcnt(15)
    buffer_load_dwordx4 v13, s[20:23], s41 offen offset:1024 nt lds
    s_waitcnt vmcnt(15)
    buffer_load_dwordx4 v14, s[20:23], s41 offen offset:2048 nt lds
    s_waitcnt vmcnt(15)
    buffer_load_dwordx4 v15, s[20:23], s41 offen offset:3072 nt lds
    s_add_u32 s41, s41, 4096
    s_and_b32 s41, s41, 0xffff
    s_waitcnt vmcnt(16)
    ds_write_b32 v28, v29 offset:4
    s_mov_b32 m0, 32768
L_k3b:
    s_waitcnt vmcnt(19)
    buffer_load_dwordx4 v12, s[20:23], s41 offen offset:0 nt lds
    s_waitcnt vmcnt(19)
    buffer_load_dwordx4 v13, s[20:23], s41 offen offset:1024 nt lds
    s_waitcnt vmcnt(19)
    buffer_load_dwordx4 v14, s[20:23], s41 offen offset:2048 nt lds
    s_waitcnt vmcnt(19)
    buffer_load_dwordx4 v15, s[20:23], s41 offen offset:3072 nt lds
    s_add_u32 s41, s41, 4096
    s_and_b32 s41, s41, 0xffff
    s_add_u32 m0, m0, 4096
    s_cmp_lt_u32 m0, 65536
    s_cbranch_scc1 L_k3b
L_v1b:
    s_waitcnt vmcnt(19)
    buffer_load_dwordx4 v16, s[24:27], s41 offen offset:0 nt lds
    s_waitcnt vmcnt(19)
    buffer_load_dwordx4 v17, s[24:27], s41 offen offset:1024 nt lds
    s_waitcnt vmcnt(19)
    buffer_load_dwordx4 v16, s[24:27], s41 offen offset:2048 nt lds
    s_waitcnt vmcnt(19)
    buffer_load_dwordx4 v17, s[24:27], s41 offen offset:3072 nt lds
    s_add_u32 s41, s41, 4096
    s_and_b32 s41, s41, 0xffff
    s_add_u32 m0, m0, 4096
    s_cmp_lt_u32 m0, 86016
    s_cbranch_scc1 L_v1b
    s_waitcnt vmcnt(19)
    ds_write_b32 v28, v29 offset:8
L_v2b:
    s_waitcnt vmcnt(23)
    buffer_load_dwordx4 v16, s[24:27], s41 offen offset:0 nt lds
    s_waitcnt vmcnt(23)
    buffer_load_dwordx4 v17, s[24:27], s41 offen offset:1024 nt lds
    s_waitcnt vmcnt(23)
    buffer_load_dwordx4 v16, s[24:27], s41 offen offset:2048 nt lds
    s_waitcnt vmcnt(23)
    buffer_load_dwordx4 v17, s[24:27], s41 offen offset:3072 nt lds
    s_add_u32 s41, s41, 4096
    s_and_b32 s41, s41, 0xffff
    s_add_u32 m0, m0, 4096
    s_cmp_lt_u32 m0, 98304
    s_cbranch_scc1 L_v2b
L_v3b:
    s_waitcnt vmcnt(23)
    buffer_load_dwordx4 v16, s[24:27], s41 offen offset:0 nt lds
    s_waitcnt vmcnt(23)
    buffer_load_dwordx4 v17, s[24:27], s41 offen offset:1024 nt lds
    s_waitcnt vmcnt(23)
    buffer_load_dwordx4 v16, s[24:27], s41 offen offset:2048 nt lds
    s_waitcnt vmcnt(23)
    buffer_load_dwordx4 v17, s[24:27], s41 offen offset:3072 nt lds
    s_add_u32 s41, s41, 4096
    s_and_b32 s41, s41, 0xffff
    s_add_u32 m0, m0, 4096
    s_cmp_lt_u32 m0, 131072
    s_cbranch_scc1 L_v3b
    s_sub_u32 s39, s37, 16
    s_cmp_lt_u32 s39, 7
    s_cbranch_scc1 L_l_mlp
    s_branch L_l_plain
L_l_light:
    s_mov_b32 m0, 147456
    s_waitcnt vmcnt(15)
    buffer_load_dwordx4 v8, s[12:15], s40 offen offset:0 nt lds
    s_waitcnt vmcnt(15)
    buffer_load_dwordx4 v9, s[12:15], s40 offen offset:1024 nt lds
    s_waitcnt vmcnt(15)
    buffer_load_dwordx4 v10, s[12:15], s40 offen offset:2048 nt lds
    s_waitcnt vmcnt(15)
    buffer_load_dwordx4 v11, s[12:15], s40 offen offset:3072 nt lds
    s_add_u32 s40, s40, 262144
    s_mov_b32 m0, 151552
    s_waitcnt vmcnt(15)
    buffer_load_dwordx4 v8, s[12:15], s40 offen offset:0 nt lds
    s_waitcnt vmcnt(15)
    buffer_load_dwordx4 v9, s[12:15], s40 offen offset:1024 nt lds
    s_waitcnt vmcnt(15)
    buffer_load_dwordx4 v10, s[12:15], s40 offen offset:2048 nt lds
    s_waitcnt vmcnt(15)
    buffer_load_dwordx4 v11, s[12:15], s40 offen offset:3072 nt lds
    s_add_u32 s40, s40, 262144
    s_mov_b32 m0, 155648
    s_waitcnt vmcnt(15)
    buffer_load_dwordx4 v8, s[12:15], s40 offen offset:0 nt lds
    s_waitcnt vmcnt(15)
    buffer_load_dwordx4 v9, s[12:15], s40 offen offset:1024 nt lds
    s_waitcnt vmcnt(15)
    buffer_load_dwordx4 v10, s[12:15], s40 offen offset:2048 nt lds
    s_waitcnt vmcnt(15)
    buffer_load_dwordx4 v11, s[12:15], s40 offen offset:3072 nt lds
    s_add_u32 s40, s40, 262144
    s_mov_b32 m0, 159744
    s_waitcnt vmcnt(15)
    buffer_load_dwordx4 v8, s[12:15], s40 offen offset:0 nt lds
    s_waitcnt vmcnt(15)
    buffer_load_dwordx4 v9, s[12:15], s40 offen offset:1024 nt lds
    s_waitcnt vmcnt(15)
    buffer_load_dwordx4 v10, s[12:15], s40 offen offset:2048 nt lds
    s_waitcnt vmcnt(15)
    buffer_load_dwordx4 v11, s[12:15], s40 offen offset:3072 nt lds
    s_mov_b32 m0, 98304
    s_waitcnt vmcnt(15)
    buffer_load_dwordx4 v4, s[8:11], s32 offen offset:0 nt lds
    s_waitcnt vmcnt(15)
    buffer_load_dwordx4 v5, s[8:11], s32 offen offset:1024 nt lds
    s_waitcnt vmcnt(15)
    buffer_load_dwordx4 v6, s[8:11], s32 offen offset:2048 nt lds
    s_waitcnt vmcnt(15)
    buffer_load_dwordx4 v7, s[8:11], s32 offen offset:3072 nt lds
    s_add_u32 s32, s32, 196608
    s_mov_b32 m0, 102400
    s_waitcnt vmcnt(15)
    buffer_load_dwordx4 v4, s[8:11], s32 offen offset:0 nt lds
    s_waitcnt vmcnt(15)
    buffer_load_dwordx4 v5, s[8:11], s32 offen offset:1024 nt lds
    s_waitcnt vmcnt(15)
    buffer_load_dwordx4 v6, s[8:11], s32 offen offset:2048 nt lds
    s_waitcnt vmcnt(15)
    buffer_load_dwordx4 v7, s[8:11], s32 offen offset:3072 nt lds
    s_add_u32 s32, s32, 196608
    s_mov_b32 m0, 106496
    s_waitcnt vmcnt(15)
    buffer_load_dwordx4 v4, s[8:11], s32 offen offset:0 nt lds
    s_waitcnt vmcnt(15)
    buffer_load_dwordx4 v5, s[8:11], s32 offen offset:1024 nt lds
    s_waitcnt vmcnt(15)
    buffer_load_dwordx4 v6, s[8:11], s32 offen offset:2048 nt lds
    s_waitcnt vmcnt(15)
    buffer_load_dwordx4 v7, s[8:11], s32 offen offset:3072 nt lds
    s_add_u32 s32, s32, 196608
    s_mov_b32 m0, 110592
    s_waitcnt vmcnt(15)
    buffer_load_dwordx4 v4, s[8:11], s32 offen offset:0 nt lds
    s_waitcnt vmcnt(15)
    buffer_load_dwordx4 v5, s[8:11], s32 offen offset:1024 nt lds
    s_waitcnt vmcnt(15)
    buffer_load_dwordx4 v6, s[8:11], s32 offen offset:2048 nt lds
    s_waitcnt vmcnt(15)
    buffer_load_dwordx4 v7, s[8:11], s32 offen offset:3072 nt lds
    s_waitcnt vmcnt(16)
    ds_write_b32 v28, v29 offset:4
    s_mov_b32 m0, 16384
    s_waitcnt vmcnt(19)
    buffer_load_dwordx4 v12, s[20:23], s41 offen offset:0 nt lds
    s_waitcnt vmcnt(19)
    buffer_load_dwordx4 v13, s[20:23], s41 offen offset:1024 nt lds
    s_waitcnt vmcnt(19)
    buffer_load_dwordx4 v14, s[20:23], s41 offen offset:2048 nt lds
    s_waitcnt vmcnt(19)
    buffer_load_dwordx4 v15, s[20:23], s41 offen offset:3072 nt lds
    s_add_u32 s41, s41, 4096
    s_and_b32 s41, s41, 0xffff
    s_mov_b32 m0, 20480
    s_waitcnt vmcnt(19)
    buffer_load_dwordx4 v12, s[20:23], s41 offen offset:0 nt lds
    s_waitcnt vmcnt(19)
    buffer_load_dwordx4 v13, s[20:23], s41 offen offset:1024 nt lds
    s_waitcnt vmcnt(19)
    buffer_load_dwordx4 v14, s[20:23], s41 offen offset:2048 nt lds
    s_waitcnt vmcnt(19)
    buffer_load_dwordx4 v15, s[20:23], s41 offen offset:3072 nt lds
    s_add_u32 s41, s41, 4096
    s_and_b32 s41, s41, 0xffff
    s_mov_b32 m0, 24576
    s_waitcnt vmcnt(19)
    buffer_load_dwordx4 v12, s[20:23], s41 offen offset:0 nt lds
    s_waitcnt vmcnt(19)
    buffer_load_dwordx4 v13, s[20:23], s41 offen offset:1024 nt lds
    s_waitcnt vmcnt(19)
    buffer_load_dwordx4 v14, s[20:23], s41 offen offset:2048 nt lds
    s_waitcnt vmcnt(19)
    buffer_load_dwordx4 v15, s[20:23], s41 offen offset:3072 nt lds
    s_add_u32 s41, s41, 4096
    s_and_b32 s41, s41, 0xffff
    s_mov_b32 m0, 28672
    s_waitcnt vmcnt(19)
    buffer_load_dwordx4 v12, s[20:23], s41 offen offset:0 nt lds
    s_waitcnt vmcnt(19)
    buffer_load_dwordx4 v13, s[20:23], s41 offen offset:1024 nt lds
    s_waitcnt vmcnt(19)
    buffer_load_dwordx4 v14, s[20:23], s41 offen offset:2048 nt lds
    s_waitcnt vmcnt(19)
    buffer_load_dwordx4 v15, s[20:23], s41 offen offset:3072 nt lds
    s_add_u32 s41, s41, 4096
    s_and_b32 s41, s41, 0xffff
    s_mov_b32 m0, 32768
    s_waitcnt vmcnt(19)
    buffer_load_dwordx4 v12, s[20:23], s41 offen offset:0 nt lds
    s_waitcnt vmcnt(19)
    buffer_load_dwordx4 v13, s[20:23], s41 offen offset:1024 nt lds
    s_waitcnt vmcnt(19)
    buffer_load_dwordx4 v14, s[20:23], s41 offen offset:2048 nt lds
    s_waitcnt vmcnt(19)
    buffer_load_dwordx4 v15, s[20:23], s41 offen offset:3072 nt lds
    s_add_u32 s41, s41, 4096
    s_and_b32 s41, s41, 0xffff
    s_waitcnt vmcnt(20)
    ds_write_b32 v28, v29 offset:224
    s_mov_b32 m0, 36864
L_k3a:
    s_waitcnt vmcnt(19)
    buffer_load_dwordx4 v12, s[20:23], s41 offen offset:0 nt lds
    s_waitcnt vmcnt(19)
    buffer_load_dwordx4 v13, s[20:23], s41 offen offset:1024 nt lds
    s_waitcnt vmcnt(19)
    buffer_load_dwordx4 v14, s[20:23], s41 offen offset:2048 nt lds
    s_waitcnt vmcnt(19)
    buffer_load_dwordx4 v15, s[20:23], s41 offen offset:3072 nt lds
    s_add_u32 s41, s41, 4096
    s_and_b32 s41, s41, 0xffff
    s_add_u32 m0, m0, 4096
    s_cmp_lt_u32 m0, 65536
    s_cbranch_scc1 L_k3a
L_v1a:
    s_waitcnt vmcnt(19)
    buffer_load_dwordx4 v16, s[24:27], s41 offen offset:0 nt lds
    s_waitcnt vmcnt(19)
    buffer_load_dwordx4 v17, s[24:27], s41 offen offset:1024 nt lds
    s_waitcnt vmcnt(19)
    buffer_load_dwordx4 v16, s[24:27], s41 offen offset:2048 nt lds
    s_waitcnt vmcnt(19)
    buffer_load_dwordx4 v17, s[24:27], s41 offen offset:3072 nt lds
    s_add_u32 s41, s41, 4096
    s_and_b32 s41, s41, 0xffff
    s_add_u32 m0, m0, 4096
    s_cmp_lt_u32 m0, 86016
    s_cbranch_scc1 L_v1a
    s_waitcnt vmcnt(19)
    ds_write_b32 v28, v29 offset:8
L_v2a:
    s_waitcnt vmcnt(31)
    buffer_load_dwordx4 v16, s[24:27], s41 offen offset:0 nt lds
    s_waitcnt vmcnt(31)
    buffer_load_dwordx4 v17, s[24:27], s41 offen offset:1024 nt lds
    s_waitcnt vmcnt(31)
    buffer_load_dwordx4 v16, s[24:27], s41 offen offset:2048 nt lds
    s_waitcnt vmcnt(31)
    buffer_load_dwordx4 v17, s[24:27], s41 offen offset:3072 nt lds
    s_add_u32 s41, s41, 4096
    s_and_b32 s41, s41, 0xffff
    s_add_u32 m0, m0, 4096
    s_cmp_lt_u32 m0, 98304
    s_cbranch_scc1 L_v2a
L_spin1:
    ds_read_b32 v32, v28 offset:228
    s_waitcnt lgkmcnt(0)
    v_cmp_eq_u32 vcc, 0, v32
    s_cbranch_vccnz L_spin1
L_v3a:
    s_waitcnt vmcnt(31)
    buffer_load_dwordx4 v16, s[24:27], s41 offen offset:0 nt lds
    s_waitcnt vmcnt(31)
    buffer_load_dwordx4 v17, s[24:27], s41 offen offset:1024 nt lds
    s_waitcnt vmcnt(31)
    buffer_load_dwordx4 v16, s[24:27], s41 offen offset:2048 nt lds
    s_waitcnt vmcnt(31)
    buffer_load_dwordx4 v17, s[24:27], s41 offen offset:3072 nt lds
    s_add_u32 s41, s41, 4096
    s_and_b32 s41, s41, 0xffff
    s_add_u32 m0, m0, 4096
    s_cmp_lt_u32 m0, 131072
    s_cbranch_scc1 L_v3a
    s_branch L_l_t1
L_l_crit:
    s_mov_b32 m0, 0
    s_waitcnt vmcnt(15)
    buffer_load_dwordx4 v12, s[20:23], s41 offen offset:0 nt lds
    s_waitcnt vmcnt(15)
    buffer_load_dwordx4 v13, s[20:23], s41 offen offset:1024 nt lds
    s_waitcnt vmcnt(15)
    buffer_load_dwordx4 v14, s[20:23], s41 offen offset:2048 nt lds
    s_waitcnt vmcnt(15)
    buffer_load_dwordx4 v15, s[20:23], s41 offen offset:3072 nt lds
    s_add_u32 s41, s41, 4096
    s_and_b32 s41, s41, 0xffff
    s_mov_b32 m0, 4096
    s_waitcnt vmcnt(15)
    buffer_load_dwordx4 v12, s[20:23], s41 offen offset:0 nt lds
    s_waitcnt vmcnt(15)
    buffer_load_dwordx4 v13, s[20:23], s41 offen offset:1024 nt lds
    s_waitcnt vmcnt(15)
    buffer_load_dwordx4 v14, s[20:23], s41 offen offset:2048 nt lds
    s_waitcnt vmcnt(15)
    buffer_load_dwordx4 v15, s[20:23], s41 offen offset:3072 nt lds
    s_add_u32 s41, s41, 4096
    s_and_b32 s41, s41, 0xffff
    s_mov_b32 m0, 8192
    s_waitcnt vmcnt(15)
    buffer_load_dwordx4 v12, s[20:23], s41 offen offset:0 nt lds
    s_waitcnt vmcnt(15)
    buffer_load_dwordx4 v13, s[20:23], s41 offen offset:1024 nt lds
    s_waitcnt vmcnt(15)
    buffer_load_dwordx4 v14, s[20:23], s41 offen offset:2048 nt lds
    s_waitcnt vmcnt(15)
    buffer_load_dwordx4 v15, s[20:23], s41 offen offset:3072 nt lds
    s_add_u32 s41, s41, 4096
    s_and_b32 s41, s41, 0xffff
    s_mov_b32 m0, 12288
    s_waitcnt vmcnt(15)
    buffer_load_dwordx4 v12, s[20:23], s41 offen offset:0 nt lds
    s_waitcnt vmcnt(15)
    buffer_load_dwordx4 v13, s[20:23], s41 offen offset:1024 nt lds
    s_waitcnt vmcnt(15)
    buffer_load_dwordx4 v14, s[20:23], s41 offen offset:2048 nt lds
    s_waitcnt vmcnt(15)
    buffer_load_dwordx4 v15, s[20:23], s41 offen offset:3072 nt lds
    s_add_u32 s41, s41, 4096
    s_and_b32 s41, s41, 0xffff
    s_waitcnt vmcnt(16)
    ds_write_b32 v28, v29 offset:0
    s_mov_b32 m0, 147456
    s_waitcnt vmcnt(15)
    buffer_load_dwordx4 v8, s[12:15], s40 offen offset:0 nt lds
    s_waitcnt vmcnt(15)
    buffer_load_dwordx4 v9, s[12:15], s40 offen offset:1024 nt lds
    s_waitcnt vmcnt(15)
    buffer_load_dwordx4 v10, s[12:15], s40 offen offset:2048 nt lds
    s_waitcnt vmcnt(15)
    buffer_load_dwordx4 v11, s[12:15], s40 offen offset:3072 nt lds
    s_add_u32 s40, s40, 262144
    s_mov_b32 m0, 151552
    s_waitcnt vmcnt(15)
    buffer_load_dwordx4 v8, s[12:15], s40 offen offset:0 nt lds
    s_waitcnt vmcnt(15)
    buffer_load_dwordx4 v9, s[12:15], s40 offen offset:1024 nt lds
    s_waitcnt vmcnt(15)
    buffer_load_dwordx4 v10, s[12:15], s40 offen offset:2048 nt lds
    s_waitcnt vmcnt(15)
    buffer_load_dwordx4 v11, s[12:15], s40 offen offset:3072 nt lds
    s_add_u32 s40, s40, 262144
    s_mov_b32 m0, 155648
    s_waitcnt vmcnt(15)
    buffer_load_dwordx4 v8, s[12:15], s40 offen offset:0 nt lds
    s_waitcnt vmcnt(15)
    buffer_load_dwordx4 v9, s[12:15], s40 offen offset:1024 nt lds
    s_waitcnt vmcnt(15)
    buffer_load_dwordx4 v10, s[12:15], s40 offen offset:2048 nt lds
    s_waitcnt vmcnt(15)
    buffer_load_dwordx4 v11, s[12:15], s40 offen offset:3072 nt lds
    s_add_u32 s40, s40, 262144
    s_mov_b32 m0, 159744
    s_waitcnt vmcnt(15)
    buffer_load_dwordx4 v8, s[12:15], s40 offen offset:0 nt lds
    s_waitcnt vmcnt(15)
    buffer_load_dwordx4 v9, s[12:15], s40 offen offset:1024 nt lds
    s_waitcnt vmcnt(15)
    buffer_load_dwordx4 v10, s[12:15], s40 offen offset:2048 nt lds
    s_waitcnt vmcnt(15)
    buffer_load_dwordx4 v11, s[12:15], s40 offen offset:3072 nt lds
    s_mov_b32 m0, 16384
    s_waitcnt vmcnt(21)
    buffer_load_dwordx4 v12, s[20:23], s41 offen offset:0 nt lds
    s_waitcnt vmcnt(21)
    buffer_load_dwordx4 v13, s[20:23], s41 offen offset:1024 nt lds
    s_waitcnt vmcnt(21)
    buffer_load_dwordx4 v14, s[20:23], s41 offen offset:2048 nt lds
    s_waitcnt vmcnt(21)
    buffer_load_dwordx4 v15, s[20:23], s41 offen offset:3072 nt lds
    s_add_u32 s41, s41, 4096
    s_and_b32 s41, s41, 0xffff
    s_mov_b32 m0, 20480
    s_waitcnt vmcnt(21)
    buffer_load_dwordx4 v12, s[20:23], s41 offen offset:0 nt lds
    s_waitcnt vmcnt(21)
    buffer_load_dwordx4 v13, s[20:23], s41 offen offset:1024 nt lds
    s_waitcnt vmcnt(21)
    buffer_load_dwordx4 v14, s[20:23], s41 offen offset:2048 nt lds
    s_waitcnt vmcnt(21)
    buffer_load_dwordx4 v15, s[20:23], s41 offen offset:3072 nt lds
    s_add_u32 s41, s41, 4096
    s_and_b32 s41, s41, 0xffff
    s_mov_b32 m0, 24576
    s_waitcnt vmcnt(21)
    buffer_load_dwordx4 v12, s[20:23], s41 offen offset:0 nt lds
    s_waitcnt vmcnt(21)
    buffer_load_dwordx4 v13, s[20:23], s41 offen offset:1024 nt lds
    s_waitcnt vmcnt(21)
    buffer_load_dwordx4 v14, s[20:23], s41 offen offset:2048 nt lds
    s_waitcnt vmcnt(21)
    buffer_load_dwordx4 v15, s[20:23], s41 offen offset:3072 nt lds
    s_add_u32 s41, s41, 4096
    s_and_b32 s41, s41, 0xffff
    s_mov_b32 m0, 28672
    s_waitcnt vmcnt(21)
    buffer_load_dwordx4 v12, s[20:23], s41 offen offset:0 nt lds
    s_waitcnt vmcnt(21)
    buffer_load_dwordx4 v13, s[20:23], s41 offen offset:1024 nt lds
    s_waitcnt vmcnt(21)
    buffer_load_dwordx4 v14, s[20:23], s41 offen offset:2048 nt lds
    s_waitcnt vmcnt(21)
    buffer_load_dwordx4 v15, s[20:23], s41 offen offset:3072 nt lds
    s_add_u32 s41, s41, 4096
    s_and_b32 s41, s41, 0xffff
    s_mov_b32 m0, 32768
    s_waitcnt vmcnt(21)
    buffer_load_dwordx4 v12, s[20:23], s41 offen offset:0 nt lds
    s_waitcnt vmcnt(21)
    buffer_load_dwordx4 v13, s[20:23], s41 offen offset:1024 nt lds
    s_waitcnt vmcnt(21)
    buffer_load_dwordx4 v14, s[20:23], s41 offen offset:2048 nt lds
    s_waitcnt vmcnt(21)
    buffer_load_dwordx4 v15, s[20:23], s41 offen offset:3072 nt lds
    s_add_u32 s41, s41, 4096
    s_and_b32 s41, s41, 0xffff
    s_mov_b32 m0, 36864
    s_waitcnt vmcnt(21)
    buffer_load_dwordx4 v12, s[20:23], s41 offen offset:0 nt lds
    s_waitcnt vmcnt(21)
    buffer_load_dwordx4 v13, s[20:23], s41 offen offset:1024 nt lds
    s_waitcnt vmcnt(21)
    buffer_load_dwordx4 v14, s[20:23], s41 offen offset:2048 nt lds
    s_waitcnt vmcnt(21)
    buffer_load_dwordx4 v15, s[20:23], s41 offen offset:3072 nt lds
    s_add_u32 s41, s41, 4096
    s_and_b32 s41, s41, 0xffff
    s_waitcnt vmcnt(24)
    ds_write_b32 v28, v29 offset:4
    s_mov_b32 m0, 40960
L_k3c:
    s_waitcnt vmcnt(21)
    buffer_load_dwordx4 v12, s[20:23], s41 offen offset:0 nt lds
    s_waitcnt vmcnt(21)
    buffer_load_dwordx4 v13, s[20:23], s41 offen offset:1024 nt lds
    s_waitcnt vmcnt(21)
    buffer_load_dwordx4 v14, s[20:23], s41 offen offset:2048 nt lds
    s_waitcnt vmcnt(21)
    buffer_load_dwordx4 v15, s[20:23], s41 offen offset:3072 nt lds
    s_add_u32 s41, s41, 4096
    s_and_b32 s41, s41, 0xffff
    s_add_u32 m0, m0, 4096
    s_cmp_lt_u32 m0, 65536
    s_cbranch_scc1 L_k3c
L_v1c:
    s_waitcnt vmcnt(21)
    buffer_load_dwordx4 v16, s[24:27], s41 offen offset:0 nt lds
    s_waitcnt vmcnt(21)
    buffer_load_dwordx4 v17, s[24:27], s41 offen offset:1024 nt lds
    s_waitcnt vmcnt(21)
    buffer_load_dwordx4 v16, s[24:27], s41 offen offset:2048 nt lds
    s_waitcnt vmcnt(21)
    buffer_load_dwordx4 v17, s[24:27], s41 offen offset:3072 nt lds
    s_add_u32 s41, s41, 4096
    s_and_b32 s41, s41, 0xffff
    s_add_u32 m0, m0, 4096
    s_cmp_lt_u32 m0, 90112
    s_cbranch_scc1 L_v1c
    s_waitcnt vmcnt(21)
    ds_write_b32 v28, v29 offset:8
L_v2c:
    s_waitcnt vmcnt(27)
    buffer_load_dwordx4 v16, s[24:27], s41 offen offset:0 nt lds
    s_waitcnt vmcnt(27)
    buffer_load_dwordx4 v17, s[24:27], s41 offen offset:1024 nt lds
    s_waitcnt vmcnt(27)
    buffer_load_dwordx4 v16, s[24:27], s41 offen offset:2048 nt lds
    s_waitcnt vmcnt(27)
    buffer_load_dwordx4 v17, s[24:27], s41 offen offset:3072 nt lds
    s_add_u32 s41, s41, 4096
    s_and_b32 s41, s41, 0xffff
    s_add_u32 m0, m0, 4096
    s_cmp_lt_u32 m0, 98304
    s_cbranch_scc1 L_v2c
L_spin2:
    ds_read_b32 v32, v28 offset:32
    s_waitcnt lgkmcnt(0)
    v_cmp_eq_u32 vcc, 0, v32
    s_cbranch_vccnz L_spin2
L_v3c:
    s_waitcnt vmcnt(27)
    buffer_load_dwordx4 v16, s[24:27], s41 offen offset:0 nt lds
    s_waitcnt vmcnt(27)
    buffer_load_dwordx4 v17, s[24:27], s41 offen offset:1024 nt lds
    s_waitcnt vmcnt(27)
    buffer_load_dwordx4 v16, s[24:27], s41 offen offset:2048 nt lds
    s_waitcnt vmcnt(27)
    buffer_load_dwordx4 v17, s[24:27], s41 offen offset:3072 nt lds
    s_add_u32 s41, s41, 4096
    s_and_b32 s41, s41, 0xffff
    s_add_u32 m0, m0, 4096
    s_cmp_lt_u32 m0, 131072
    s_cbranch_scc1 L_v3c
    s_cmp_eq_u32 s37, 31
    s_cbranch_scc1 L_l_plain
    s_sub_u32 s37, s37, 8
    v_and_b32 v26, 1, v2
    v_lshlrev_b32 v26, 1, v26
    v_and_b32 v27, 3, v1
    v_xor_b32 v26, v26, v27
    v_lshlrev_b32 v26, 4, v26
    v_lshrrev_b32 v27, 2, v1
    v_mul_u32_u24 v27, 3584, v27
    v_add_u32 v22, v26, v27
    v_add_u32 v23, 56320, v22
    v_add_u32 v24, 112640, v22
    v_add_u32 v25, 168960, v22
    s_mov_b32 s6, 1835008
    s_mov_b32 s7, 0x20000
    s_mov_b32 s30, 1835008
    s_mov_b32 s31, 0x20000
L_spin3:
    ds_read_b128 v[32:35], v28 offset:16
    s_waitcnt lgkmcnt(0)
    v_min3_u32 v36, v32, v33, v34
    v_min_u32 v36, v36, v35
    v_cmp_eq_u32 vcc, 0, v36
    s_cbranch_vccnz L_spin3
    s_mul_i32 s55, s36, 7
    s_add_u32 s55, s55, s37
    s_sub_u32 s55, s55, 16
    s_lshl_b32 s39, s55, 6
    s_lshl_b32 s40, s55, 15
    s_mov_b32 m0, 0
    s_add_u32 s39, s39, 1835008
    s_waitcnt vmcnt(8)
    ds_write_b32 v28, v29 offset:40
    s_waitcnt vmcnt(0)
    s_barrier
    s_barrier
    s_waitcnt vmcnt(39)
    buffer_load_dwordx4 v18, s[28:31], s40 offen offset:0  lds
    s_waitcnt vmcnt(39)
    buffer_load_dwordx4 v19, s[28:31], s40 offen offset:1024  lds
    s_waitcnt vmcnt(39)
    buffer_load_dwordx4 v20, s[28:31], s40 offen offset:2048  lds
    s_waitcnt vmcnt(39)
    buffer_load_dwordx4 v21, s[28:31], s40 offen offset:3072  lds
    s_add_u32 s40, s40, 16384
    s_add_u32 m0, m0, 4096
    s_waitcnt vmcnt(39)
    buffer_load_dwordx4 v18, s[28:31], s40 offen offset:0  lds
    s_waitcnt vmcnt(39)
    buffer_load_dwordx4 v19, s[28:31], s40 offen offset:1024  lds
    s_waitcnt vmcnt(39)
    buffer_load_dwordx4 v20, s[28:31], s40 offen offset:2048  lds
    s_waitcnt vmcnt(39)
    buffer_load_dwordx4 v21, s[28:31], s40 offen offset:3072  lds
    s_sub_u32 s40, s40, 16128
    s_add_u32 m0, m0, 4096
    s_waitcnt vmcnt(39)
    buffer_load_dwordx4 v18, s[28:31], s40 offen offset:0  lds
    s_waitcnt vmcnt(39)
    buffer_load_dwordx4 v19, s[28:31], s40 offen offset:1024  lds
    s_waitcnt vmcnt(39)
    buffer_load_dwordx4 v20, s[28:31], s40 offen offset:2048  lds
    s_waitcnt vmcnt(39)
    buffer_load_dwordx4 v21, s[28:31], s40 offen offset:3072  lds
    s_add_u32 s40, s40, 16384
    s_add_u32 m0, m0, 4096
    s_waitcnt vmcnt(39)
    buffer_load_dwordx4 v18, s[28:31], s40 offen offset:0  lds
    s_waitcnt vmcnt(39)
    buffer_load_dwordx4 v19, s[28:31], s40 offen offset:1024  lds
    s_waitcnt vmcnt(39)
    buffer_load_dwordx4 v20, s[28:31], s40 offen offset:2048  lds
    s_waitcnt vmcnt(39)
    buffer_load_dwordx4 v21, s[28:31], s40 offen offset:3072  lds
    s_sub_u32 s40, s40, 16128
    s_add_u32 m0, m0, 4096
    s_waitcnt vmcnt(39)
    buffer_load_dwordx4 v18, s[28:31], s40 offen offset:0  lds
    s_waitcnt vmcnt(39)
    buffer_load_dwordx4 v19, s[28:31], s40 offen offset:1024  lds
    s_waitcnt vmcnt(39)
    buffer_load_dwordx4 v20, s[28:31], s40 offen offset:2048  lds
    s_waitcnt vmcnt(39)
    buffer_load_dwordx4 v21, s[28:31], s40 offen offset:3072  lds
    s_add_u32 s40, s40, 16384
    s_add_u32 m0, m0, 4096
    s_waitcnt vmcnt(39)
    buffer_load_dwordx4 v18, s[28:31], s40 offen offset:0  lds
    s_waitcnt vmcnt(39)
    buffer_load_dwordx4 v19, s[28:31], s40 offen offset:1024  lds
    s_waitcnt vmcnt(39)
    buffer_load_dwordx4 v20, s[28:31], s40 offen offset:2048  lds
    s_waitcnt vmcnt(39)
    buffer_load_dwordx4 v21, s[28:31], s40 offen offset:3072  lds
    s_sub_u32 s40, s40, 16128
    s_add_u32 m0, m0, 4096
    s_waitcnt vmcnt(39)
    buffer_load_dwordx4 v18, s[28:31], s40 offen offset:0  lds
    s_waitcnt vmcnt(39)
    buffer_load_dwordx4 v19, s[28:31], s40 offen offset:1024  lds
    s_waitcnt vmcnt(39)
    buffer_load_dwordx4 v20, s[28:31], s40 offen offset:2048  lds
    s_waitcnt vmcnt(39)
    buffer_load_dwordx4 v21, s[28:31], s40 offen offset:3072  lds
    s_add_u32 s40, s40, 16384
    s_add_u32 m0, m0, 4096
    s_waitcnt vmcnt(39)
    buffer_load_dwordx4 v18, s[28:31], s40 offen offset:0  lds
    s_waitcnt vmcnt(39)
    buffer_load_dwordx4 v19, s[28:31], s40 offen offset:1024  lds
    s_waitcnt vmcnt(39)
    buffer_load_dwordx4 v20, s[28:31], s40 offen offset:2048  lds
    s_waitcnt vmcnt(39)
    buffer_load_dwordx4 v21, s[28:31], s40 offen offset:3072  lds
    s_branch L_l_end
L_l_plain:
    s_waitcnt vmcnt(8)
    ds_write_b32 v28, v29 offset:40
    s_waitcnt vmcnt(0)
    s_barrier
L_l_end:
    s_endpgm

L_l_t1:
L_spin4:
    ds_read_b128 v[32:35], v28 offset:16
    s_waitcnt lgkmcnt(0)
    v_min3_u32 v36, v32, v33, v34
    v_min_u32 v36, v36, v35
    v_cmp_eq_u32 vcc, 0, v36
    s_cbranch_vccnz L_spin4
    s_mov_b32 s6, 4194304
    s_mov_b32 s7, 0x20000
    s_lshr_b32 s40, s37, 2
    s_and_b32 s42, s37, 3
    s_lshl_b32 s39, s36, 19
    s_lshl_b32 s59, s40, 17
    s_add_u32 s39, s39, s59
    s_lshl_b32 s59, s42, 8
    s_add_u32 s39, s39, s59
    s_mov_b32 m0, 0
    s_waitcnt vmcnt(31)
    buffer_load_dwordx4 v18, s[4:7], s39 offen offset:0 nt lds
    s_waitcnt vmcnt(31)
    buffer_load_dwordx4 v19, s[4:7], s39 offen offset:1024 nt lds
    s_waitcnt vmcnt(31)
    buffer_load_dwordx4 v20, s[4:7], s39 offen offset:2048 nt lds
    s_waitcnt vmcnt(31)
    buffer_load_dwordx4 v21, s[4:7], s39 offen offset:3072 nt lds
    s_add_u32 s39, s39, 16384
    s_add_u32 m0, m0, 4096
    s_waitcnt vmcnt(31)
    buffer_load_dwordx4 v18, s[4:7], s39 offen offset:0 nt lds
    s_waitcnt vmcnt(31)
    buffer_load_dwordx4 v19, s[4:7], s39 offen offset:1024 nt lds
    s_waitcnt vmcnt(31)
    buffer_load_dwordx4 v20, s[4:7], s39 offen offset:2048 nt lds
    s_waitcnt vmcnt(31)
    buffer_load_dwordx4 v21, s[4:7], s39 offen offset:3072 nt lds
    s_add_u32 s39, s39, 16384
    s_add_u32 m0, m0, 4096
    s_waitcnt vmcnt(31)
    buffer_load_dwordx4 v18, s[4:7], s39 offen offset:0 nt lds
    s_waitcnt vmcnt(31)
    buffer_load_dwordx4 v19, s[4:7], s39 offen offset:1024 nt lds
    s_waitcnt vmcnt(31)
    buffer_load_dwordx4 v20, s[4:7], s39 offen offset:2048 nt lds
    s_waitcnt vmcnt(31)
    buffer_load_dwordx4 v21, s[4:7], s39 offen offset:3072 nt lds
    s_add_u32 s39, s39, 16384
    s_add_u32 m0, m0, 4096
    s_waitcnt vmcnt(31)
    buffer_load_dwordx4 v18, s[4:7], s39 offen offset:0 nt lds
    s_waitcnt vmcnt(31)
    buffer_load_dwordx4 v19, s[4:7], s39 offen offset:1024 nt lds
    s_waitcnt vmcnt(31)
    buffer_load_dwordx4 v20, s[4:7], s39 offen offset:2048 nt lds
    s_waitcnt vmcnt(31)
    buffer_load_dwordx4 v21, s[4:7], s39 offen offset:3072 nt lds
    s_add_u32 s39, s39, 16384
    s_add_u32 m0, m0, 4096
    s_waitcnt vmcnt(31)
    buffer_load_dwordx4 v18, s[4:7], s39 offen offset:0 nt lds
    s_waitcnt vmcnt(31)
    buffer_load_dwordx4 v19, s[4:7], s39 offen offset:1024 nt lds
    s_waitcnt vmcnt(31)
    buffer_load_dwordx4 v20, s[4:7], s39 offen offset:2048 nt lds
    s_waitcnt vmcnt(31)
    buffer_load_dwordx4 v21, s[4:7], s39 offen offset:3072 nt lds
    s_add_u32 s39, s39, 16384
    s_add_u32 m0, m0, 4096
    s_waitcnt vmcnt(31)
    buffer_load_dwordx4 v18, s[4:7], s39 offen offset:0 nt lds
    s_waitcnt vmcnt(31)
    buffer_load_dwordx4 v19, s[4:7], s39 offen offset:1024 nt lds
    s_waitcnt vmcnt(31)
    buffer_load_dwordx4 v20, s[4:7], s39 offen offset:2048 nt lds
    s_waitcnt vmcnt(31)
    buffer_load_dwordx4 v21, s[4:7], s39 offen offset:3072 nt lds
    s_add_u32 s39, s39, 16384
    s_add_u32 m0, m0, 4096
    s_waitcnt vmcnt(31)
    buffer_load_dwordx4 v18, s[4:7], s39 offen offset:0 nt lds
    s_waitcnt vmcnt(31)
    buffer_load_dwordx4 v19, s[4:7], s39 offen offset:1024 nt lds
    s_waitcnt vmcnt(31)
    buffer_load_dwordx4 v20, s[4:7], s39 offen offset:2048 nt lds
    s_waitcnt vmcnt(31)
    buffer_load_dwordx4 v21, s[4:7], s39 offen offset:3072 nt lds
    s_add_u32 s39, s39, 16384
    s_add_u32 m0, m0, 4096
    s_waitcnt vmcnt(31)
    buffer_load_dwordx4 v18, s[4:7], s39 offen offset:0 nt lds
    s_waitcnt vmcnt(31)
    buffer_load_dwordx4 v19, s[4:7], s39 offen offset:1024 nt lds
    s_waitcnt vmcnt(31)
    buffer_load_dwordx4 v20, s[4:7], s39 offen offset:2048 nt lds
    s_waitcnt vmcnt(31)
    buffer_load_dwordx4 v21, s[4:7], s39 offen offset:3072 nt lds
    s_waitcnt vmcnt(40)
    ds_write_b32 v28, v29 offset:40
    s_waitcnt vmcnt(32)
    s_barrier
    s_barrier
    s_waitcnt vmcnt(0)
    s_barrier
    s_branch L_l_end

L_l_mlp:
    v_and_b32 v26, 1, v2
    v_lshlrev_b32 v26, 1, v26
    v_and_b32 v27, 3, v1
    v_xor_b32 v26, v26, v27
    v_lshlrev_b32 v26, 4, v26
    v_lshrrev_b32 v27, 2, v1
    v_mul_u32_u24 v27, 3584, v27
    v_add_u32 v22, v26, v27
    v_add_u32 v23, 56320, v22
    v_add_u32 v24, 112640, v22
    v_add_u32 v25, 168960, v22
    s_mov_b32 s6, 1835008
    s_mov_b32 s7, 0x20000
    s_mov_b32 s30, 1835008
    s_mov_b32 s31, 0x20000
L_spin5:
    ds_read_b128 v[32:35], v28 offset:16
    s_waitcnt lgkmcnt(0)
    v_min3_u32 v36, v32, v33, v34
    v_min_u32 v36, v36, v35
    v_cmp_eq_u32 vcc, 0, v36
    s_cbranch_vccnz L_spin5
    s_mul_i32 s55, s36, 7
    s_add_u32 s55, s55, s37
    s_sub_u32 s55, s55, 16
    s_lshl_b32 s39, s55, 6
    s_lshl_b32 s40, s55, 15
    s_mov_b32 m0, 0
    s_waitcnt vmcnt(8)
    ds_write_b32 v28, v29 offset:40
    s_waitcnt vmcnt(0)
    s_barrier
    s_barrier
    s_waitcnt vmcnt(15)
    buffer_load_dwordx4 v22, s[4:7], s39 offen offset:0 nt lds
    s_waitcnt vmcnt(15)
    buffer_load_dwordx4 v23, s[4:7], s39 offen offset:1024 nt lds
    s_waitcnt vmcnt(15)
    buffer_load_dwordx4 v24, s[4:7], s39 offen offset:2048 nt lds
    s_waitcnt vmcnt(15)
    buffer_load_dwordx4 v25, s[4:7], s39 offen offset:3072 nt lds
    s_add_u32 s39, s39, 229376
    s_add_u32 m0, m0, 4096
    s_waitcnt vmcnt(15)
    buffer_load_dwordx4 v22, s[4:7], s39 offen offset:0 nt lds
    s_waitcnt vmcnt(15)
    buffer_load_dwordx4 v23, s[4:7], s39 offen offset:1024 nt lds
    s_waitcnt vmcnt(15)
    buffer_load_dwordx4 v24, s[4:7], s39 offen offset:2048 nt lds
    s_waitcnt vmcnt(15)
    buffer_load_dwordx4 v25, s[4:7], s39 offen offset:3072 nt lds
    s_add_u32 s39, s39, 229376
    s_add_u32 m0, m0, 4096
    s_waitcnt vmcnt(15)
    buffer_load_dwordx4 v22, s[4:7], s39 offen offset:0 nt lds
    s_waitcnt vmcnt(15)
    buffer_load_dwordx4 v23, s[4:7], s39 offen offset:1024 nt lds
    s_waitcnt vmcnt(15)
    buffer_load_dwordx4 v24, s[4:7], s39 offen offset:2048 nt lds
    s_waitcnt vmcnt(15)
    buffer_load_dwordx4 v25, s[4:7], s39 offen offset:3072 nt lds
    s_add_u32 s39, s39, 229376
    s_add_u32 m0, m0, 4096
    s_waitcnt vmcnt(15)
    buffer_load_dwordx4 v22, s[4:7], s39 offen offset:0 nt lds
    s_waitcnt vmcnt(15)
    buffer_load_dwordx4 v23, s[4:7], s39 offen offset:1024 nt lds
    s_waitcnt vmcnt(15)
    buffer_load_dwordx4 v24, s[4:7], s39 offen offset:2048 nt lds
    s_waitcnt vmcnt(15)
    buffer_load_dwordx4 v25, s[4:7], s39 offen offset:3072 nt lds
    s_add_u32 s39, s39, 229376
    s_add_u32 m0, m0, 4096
    s_waitcnt vmcnt(15)
    buffer_load_dwordx4 v22, s[4:7], s39 offen offset:0 nt lds
    s_waitcnt vmcnt(15)
    buffer_load_dwordx4 v23, s[4:7], s39 offen offset:1024 nt lds
    s_waitcnt vmcnt(15)
    buffer_load_dwordx4 v24, s[4:7], s39 offen offset:2048 nt lds
    s_waitcnt vmcnt(15)
    buffer_load_dwordx4 v25, s[4:7], s39 offen offset:3072 nt lds
    s_add_u32 s39, s39, 229376
    s_add_u32 m0, m0, 4096
    s_waitcnt vmcnt(15)
    buffer_load_dwordx4 v22, s[4:7], s39 offen offset:0 nt lds
    s_waitcnt vmcnt(15)
    buffer_load_dwordx4 v23, s[4:7], s39 offen offset:1024 nt lds
    s_waitcnt vmcnt(15)
    buffer_load_dwordx4 v24, s[4:7], s39 offen offset:2048 nt lds
    s_waitcnt vmcnt(15)
    buffer_load_dwordx4 v25, s[4:7], s39 offen offset:3072 nt lds
    s_add_u32 s39, s39, 229376
    s_add_u32 m0, m0, 4096
    s_waitcnt vmcnt(15)
    buffer_load_dwordx4 v22, s[4:7], s39 offen offset:0 nt lds
    s_waitcnt vmcnt(15)
    buffer_load_dwordx4 v23, s[4:7], s39 offen offset:1024 nt lds
    s_waitcnt vmcnt(15)
    buffer_load_dwordx4 v24, s[4:7], s39 offen offset:2048 nt lds
    s_waitcnt vmcnt(15)
    buffer_load_dwordx4 v25, s[4:7], s39 offen offset:3072 nt lds
    s_add_u32 s39, s39, 229376
    s_add_u32 m0, m0, 4096
    s_waitcnt vmcnt(15)
    buffer_load_dwordx4 v22, s[4:7], s39 offen offset:0 nt lds
    s_waitcnt vmcnt(15)
    buffer_load_dwordx4 v23, s[4:7], s39 offen offset:1024 nt lds
    s_waitcnt vmcnt(15)
    buffer_load_dwordx4 v24, s[4:7], s39 offen offset:2048 nt lds
    s_waitcnt vmcnt(15)
    buffer_load_dwordx4 v25, s[4:7], s39 offen offset:3072 nt lds
    s_add_u32 s39, s39, 229376
    s_add_u32 m0, m0, 4096
    s_mov_b32 m0, 32768
    s_waitcnt vmcnt(39)
    buffer_load_dwordx4 v18, s[28:31], s40 offen offset:0 nt lds
    s_waitcnt vmcnt(39)
    buffer_load_dwordx4 v19, s[28:31], s40 offen offset:1024 nt lds
    s_waitcnt vmcnt(39)
    buffer_load_dwordx4 v20, s[28:31], s40 offen offset:2048 nt lds
    s_waitcnt vmcnt(39)
    buffer_load_dwordx4 v21, s[28:31], s40 offen offset:3072 nt lds
    s_add_u32 s40, s40, 16384
    s_add_u32 m0, m0, 4096
    s_waitcnt vmcnt(39)
    buffer_load_dwordx4 v18, s[28:31], s40 offen offset:0 nt lds
    s_waitcnt vmcnt(39)
    buffer_load_dwordx4 v19, s[28:31], s40 offen offset:1024 nt lds
    s_waitcnt vmcnt(39)
    buffer_load_dwordx4 v20, s[28:31], s40 offen offset:2048 nt lds
    s_waitcnt vmcnt(39)
    buffer_load_dwordx4 v21, s[28:31], s40 offen offset:3072 nt lds
    s_sub_u32 s40, s40, 16128
    s_add_u32 m0, m0, 4096
    s_waitcnt vmcnt(39)
    buffer_load_dwordx4 v18, s[28:31], s40 offen offset:0 nt lds
    s_waitcnt vmcnt(39)
    buffer_load_dwordx4 v19, s[28:31], s40 offen offset:1024 nt lds
    s_waitcnt vmcnt(39)
    buffer_load_dwordx4 v20, s[28:31], s40 offen offset:2048 nt lds
    s_waitcnt vmcnt(39)
    buffer_load_dwordx4 v21, s[28:31], s40 offen offset:3072 nt lds
    s_add_u32 s40, s40, 16384
    s_add_u32 m0, m0, 4096
    s_waitcnt vmcnt(39)
    buffer_load_dwordx4 v18, s[28:31], s40 offen offset:0 nt lds
    s_waitcnt vmcnt(39)
    buffer_load_dwordx4 v19, s[28:31], s40 offen offset:1024 nt lds
    s_waitcnt vmcnt(39)
    buffer_load_dwordx4 v20, s[28:31], s40 offen offset:2048 nt lds
    s_waitcnt vmcnt(39)
    buffer_load_dwordx4 v21, s[28:31], s40 offen offset:3072 nt lds
    s_sub_u32 s40, s40, 16128
    s_add_u32 m0, m0, 4096
    s_waitcnt vmcnt(39)
    buffer_load_dwordx4 v18, s[28:31], s40 offen offset:0 nt lds
    s_waitcnt vmcnt(39)
    buffer_load_dwordx4 v19, s[28:31], s40 offen offset:1024 nt lds
    s_waitcnt vmcnt(39)
    buffer_load_dwordx4 v20, s[28:31], s40 offen offset:2048 nt lds
    s_waitcnt vmcnt(39)
    buffer_load_dwordx4 v21, s[28:31], s40 offen offset:3072 nt lds
    s_add_u32 s40, s40, 16384
    s_add_u32 m0, m0, 4096
    s_waitcnt vmcnt(39)
    buffer_load_dwordx4 v18, s[28:31], s40 offen offset:0 nt lds
    s_waitcnt vmcnt(39)
    buffer_load_dwordx4 v19, s[28:31], s40 offen offset:1024 nt lds
    s_waitcnt vmcnt(39)
    buffer_load_dwordx4 v20, s[28:31], s40 offen offset:2048 nt lds
    s_waitcnt vmcnt(39)
    buffer_load_dwordx4 v21, s[28:31], s40 offen offset:3072 nt lds
    s_sub_u32 s40, s40, 16128
    s_add_u32 m0, m0, 4096
    s_waitcnt vmcnt(39)
    buffer_load_dwordx4 v18, s[28:31], s40 offen offset:0 nt lds
    s_waitcnt vmcnt(39)
    buffer_load_dwordx4 v19, s[28:31], s40 offen offset:1024 nt lds
    s_waitcnt vmcnt(39)
    buffer_load_dwordx4 v20, s[28:31], s40 offen offset:2048 nt lds
    s_waitcnt vmcnt(39)
    buffer_load_dwordx4 v21, s[28:31], s40 offen offset:3072 nt lds
    s_add_u32 s40, s40, 16384
    s_add_u32 m0, m0, 4096
    s_waitcnt vmcnt(39)
    buffer_load_dwordx4 v18, s[28:31], s40 offen offset:0 nt lds
    s_waitcnt vmcnt(39)
    buffer_load_dwordx4 v19, s[28:31], s40 offen offset:1024 nt lds
    s_waitcnt vmcnt(39)
    buffer_load_dwordx4 v20, s[28:31], s40 offen offset:2048 nt lds
    s_waitcnt vmcnt(39)
    buffer_load_dwordx4 v21, s[28:31], s40 offen offset:3072 nt lds
    s_waitcnt vmcnt(0)
    s_barrier
    s_branch L_l_end
L_notloader:
    s_load_dwordx2 s[16:17], s[0:1], 96
    s_load_dwordx2 s[28:29], s[0:1], 0
    s_cmp_lg_u32 s3, 1
    s_cbranch_scc1 L_compute

    s_setprio 2
    s_load_dwordx2 s[4:5], s[0:1], 64
    s_lshr_b32 s35, s37, 3
    s_bfe_u32 s34, s2, 0x40002
    s_and_b32 s33, s2, 3
    v_and_b32 v4, 1, v3
    v_lshlrev_b32 v4, 10, v4
    v_lshrrev_b32 v5, 1, v3
    v_lshl_or_b32 v4, v5, 5, v4
    v_lshl_or_b32 v4, v2, 3, v4
    v_lshlrev_b32 v208, 4, v1
    v_mov_b32 v6, 0
    v_lshlrev_b32 v7, 2, v1
    s_mov_b32 s18, 1769472
    s_mov_b32 s19, 0x20000
    s_mov_b32 s6, 2048
    s_mov_b32 s7, 0x20000
    s_mov_b32 s30, 2048
    s_mov_b32 s31, 0x20000
    s_lshl_b32 s39, s33, 8
    s_lshl_b32 s40, s35, 8
    s_waitcnt lgkmcnt(0)
    buffer_load_dword v8, v6, s[16:19], 0 offen sc1
    buffer_load_dwordx2 v[10:11], v4, s[4:7], s39 offen
    buffer_load_dwordx4 v[12:15], v208, s[28:31], 0 offen
    buffer_load_dwordx4 v[16:19], v208, s[28:31], 0 offen offset:1024
    v_mov_b32 v188, -1
    v_mov_b32 v189, -1
    v_mov_b32 v190, -1
    v_mov_b32 v191, -1
    v_mov_b32 v211, 131072
    v_mov_b32 v212, 1

    s_lshl_b32 s39, s36, 15
    s_lshl_b32 s59, s37, 10
    s_add_u32 s39, s39, s59
    s_add_u32 s39, s39, 655360
    buffer_load_dwordx4 v[108:111], v208, s[16:19], s39 offen
    buffer_store_dwordx4 v[188:191], v208, s[16:19], s39 offen
    v_and_b32 v4, 1, v2
    v_lshlrev_b32 v4, 13, v4
    v_lshrrev_b32 v5, 1, v2
    v_lshl_or_b32 v4, v5, 6, v4
    v_and_b32 v5, 1, v3
    v_lshl_or_b32 v4, v5, 7, v4
    v_cmp_eq_u32 s[48:49], 1, v5
    v_lshrrev_b32 v5, 1, v3
    v_lshl_or_b32 v220, v5, 3, v4
    s_and_b32 s56, s37, 7
    s_lshl_b32 s32, s36, 14
    s_lshl_b32 s59, s35, 11
    s_add_u32 s32, s32, s59
    s_lshl_b32 s59, s56, 8
    s_add_u32 s32, s32, s59
    s_add_u32 s32, s32, 131072
    s_cmp_lg_u32 s46, 0
    s_cbranch_scc1 L_h_c2
    s_lshl_b32 s39, s36, 10
    s_lshl_b32 s59, s45, 9
    s_add_u32 s39, s39, s59
    s_add_u32 s39, s39, 1179648
    s_mov_b32 exec_lo, 0xffffffff
    s_mov_b32 exec_hi, 0x0
    buffer_load_dwordx4 v[112:115], v208, s[16:19], s39 offen
    buffer_store_dwordx4 v[188:191], v208, s[16:19], s39 offen
    s_mov_b64 exec, -1
L_h_c2:
    s_cmp_ge_u32 s37, 16
    s_cbranch_scc1 L_h_c3
    s_mul_i32 s39, s36, 8448
    s_lshl_b32 s59, s37, 9
    s_add_u32 s39, s39, s59
    s_add_u32 s39, s39, 1196032
    s_mul_i32 s40, s37, -496
    s_add_u32 s40, s40, 8192
    v_mov_b32 v4, v208
    v_writelane_b32 v4, s40, 32
    s_mov_b32 exec_lo, 0xffffffff
    s_mov_b32 exec_hi, 0x1
    buffer_load_dwordx4 v[116:119], v4, s[16:19], s39 offen
    buffer_store_dwordx4 v[188:191], v4, s[16:19], s39 offen
    s_mov_b64 exec, -1
L_h_c3:
    s_getpc_b64 s[24:25]
L_pc:
    s_sub_u32 s24, s24, L_pc-adaLN_cond__sliding_block_cached__dense_activation_silu__decode_kernel
    s_subb_u32 s25, s25, 0
    s_mov_b32 s26, L_code_end-adaLN_cond__sliding_block_cached__dense_activation_silu__decode_kernel
    s_mov_b32 s27, 0x20000
    v_lshlrev_b32 v5, 7, v1
    s_mul_i32 s39, s37, 768
    s_mov_b64 exec, 0x3f
    buffer_load_dword v210, v5, s[24:27], s39 offen
    s_mov_b64 exec, -1
    s_barrier
    v_lshrrev_b32 v4, 2, v1
    v_bfe_u32 v5, v1, 3, 2
    v_lshlrev_b32 v5, 5, v5
    v_lshl_or_b32 v4, v4, 7, v5
    v_and_b32 v5, 3, v1
    v_lshl_or_b32 v4, v5, 3, v4
    v_add_u32 v22, 114688, v4
    v_xor_b32 v23, 32, v22
    v_xor_b32 v24, 64, v22
    v_xor_b32 v25, 96, v22
    s_getreg_b32 s92, hwreg(HW_REG_XCC_ID, 0, 3)
    s_mov_b32 s95, 0x3f80
    s_mov_b32 s93, 0x3f800000
    s_waitcnt vmcnt(5)
    v_readfirstlane_b32 s43, v8
    s_nop 0
    s_add_u32 s43, s43, 0x9E3779B1
    s_add_u32 s92, s92, s43

    s_cmp_lt_u32 s37, 24
    s_cbranch_scc1 L_h_m1
    v_lshlrev_b32 v196, 16, v10
    v_and_b32 v197, 0xffff0000, v10
    v_lshlrev_b32 v198, 16, v11
    v_and_b32 v199, 0xffff0000, v11
    v_mul_f32 v200, 0xbfb8aa3b, v196
    v_mul_f32 v201, 0xbfb8aa3b, v197
    v_mul_f32 v202, 0xbfb8aa3b, v198
    v_mul_f32 v203, 0xbfb8aa3b, v199
    v_exp_f32 v200, v200
    v_exp_f32 v201, v201
    v_exp_f32 v202, v202
    v_exp_f32 v203, v203
    v_add_f32 v200, 1.0, v200
    v_add_f32 v201, 1.0, v201
    v_add_f32 v202, 1.0, v202
    v_add_f32 v203, 1.0, v203
    v_rcp_f32 v200, v200
    v_rcp_f32 v201, v201
    v_rcp_f32 v202, v202
    v_rcp_f32 v203, v203
    v_mul_f32 v196, v196, v200
    v_mul_f32 v197, v197, v201
    v_mul_f32 v198, v198, v202
    v_mul_f32 v199, v199, v203
    v_cvt_pk_bf16_f32 v28, v196, v197
    v_cvt_pk_bf16_f32 v29, v198, v199
    s_nop 0
    v_mov_b32_dpp v30, v28 row_shl:2 row_mask:0xf bank_mask:0xf bound_ctrl:1
    v_mov_b32_dpp v31, v29 row_shl:2 row_mask:0xf bank_mask:0xf bound_ctrl:1
    v_mov_b32_dpp v32, v28 row_shl:4 row_mask:0xf bank_mask:0xf bound_ctrl:1
    v_mov_b32_dpp v33, v29 row_shl:4 row_mask:0xf bank_mask:0xf bound_ctrl:1
    v_mov_b32_dpp v34, v28 row_shl:6 row_mask:0xf bank_mask:0xf bound_ctrl:1
    v_mov_b32_dpp v35, v29 row_shl:6 row_mask:0xf bank_mask:0xf bound_ctrl:1
    v_mov_b32_dpp v36, v28 row_shl:8 row_mask:0xf bank_mask:0xf bound_ctrl:1
    v_mov_b32_dpp v37, v29 row_shl:8 row_mask:0xf bank_mask:0xf bound_ctrl:1
    v_mov_b32_dpp v38, v28 row_shl:10 row_mask:0xf bank_mask:0xf bound_ctrl:1
    v_mov_b32_dpp v39, v29 row_shl:10 row_mask:0xf bank_mask:0xf bound_ctrl:1
    v_mov_b32_dpp v40, v28 row_shl:12 row_mask:0xf bank_mask:0xf bound_ctrl:1
    v_mov_b32_dpp v41, v29 row_shl:12 row_mask:0xf bank_mask:0xf bound_ctrl:1
    v_mov_b32_dpp v42, v28 row_shl:14 row_mask:0xf bank_mask:0xf bound_ctrl:1
    v_mov_b32_dpp v43, v29 row_shl:14 row_mask:0xf bank_mask:0xf bound_ctrl:1
    s_lshl_b32 s39, s34, 11
    s_lshl_b32 s59, s33, 9
    s_add_u32 s39, s39, s59
    s_add_u32 s39, s39, 4096
    v_lshlrev_b32 v4, 3, v1
    v_mov_b32 v197, s43
L_spin6:
    ds_read_b32 v5, v211 offset:0
    s_waitcnt lgkmcnt(0)
    v_cmp_eq_u32 vcc, 0, v5
    s_cbranch_vccnz L_spin6
    ds_read_b64_tr_b16 v[44:45], v22 offset:0
    ds_read_b64_tr_b16 v[46:47], v22 offset:2048
    ds_read_b64_tr_b16 v[48:49], v23 offset:0
    ds_read_b64_tr_b16 v[50:51], v23 offset:2048
    ds_read_b64_tr_b16 v[52:53], v24 offset:0
    ds_read_b64_tr_b16 v[54:55], v24 offset:2048
    ds_read_b64_tr_b16 v[56:57], v25 offset:0
    ds_read_b64_tr_b16 v[58:59], v25 offset:2048
    ds_read_b64_tr_b16 v[60:61], v22 offset:4096
    ds_read_b64_tr_b16 v[62:63], v22 offset:6144
    ds_read_b64_tr_b16 v[64:65], v23 offset:4096
    ds_read_b64_tr_b16 v[66:67], v23 offset:6144
    ds_read_b64_tr_b16 v[68:69], v24 offset:4096
    ds_read_b64_tr_b16 v[70:71], v24 offset:6144
    ds_read_b64_tr_b16 v[72:73], v25 offset:4096
    ds_read_b64_tr_b16 v[74:75], v25 offset:6144
    ds_read_b64_tr_b16 v[76:77], v22 offset:8192
    ds_read_b64_tr_b16 v[78:79], v22 offset:10240
    ds_read_b64_tr_b16 v[80:81], v23 offset:8192
    ds_read_b64_tr_b16 v[82:83], v23 offset:10240
    ds_read_b64_tr_b16 v[84:85], v24 offset:8192
    ds_read_b64_tr_b16 v[86:87], v24 offset:10240
    ds_read_b64_tr_b16 v[88:89], v25 offset:8192
    ds_read_b64_tr_b16 v[90:91], v25 offset:10240
    ds_read_b64_tr_b16 v[92:93], v22 offset:12288
    ds_read_b64_tr_b16 v[94:95], v22 offset:14336
    ds_read_b64_tr_b16 v[96:97], v23 offset:12288
    ds_read_b64_tr_b16 v[98:99], v23 offset:14336
    ds_read_b64_tr_b16 v[100:101], v24 offset:12288
    ds_read_b64_tr_b16 v[102:103], v24 offset:14336
    ds_read_b64_tr_b16 v[104:105], v25 offset:12288
    ds_read_b64_tr_b16 v[106:107], v25 offset:14336
    ds_write_b32 v211, v212 offset:32
    s_waitcnt lgkmcnt(15)
    v_mfma_f32_16x16x32_bf16 v[172:175], v[28:31], v[44:47], 0
    v_mfma_f32_16x16x32_bf16 v[176:179], v[28:31], v[48:51], 0
    v_mfma_f32_16x16x32_bf16 v[180:183], v[28:31], v[52:55], 0
    v_mfma_f32_16x16x32_bf16 v[184:187], v[28:31], v[56:59], 0
    s_waitcnt lgkmcnt(15)
    v_mfma_f32_16x16x32_bf16 v[172:175], v[32:35], v[60:63], v[172:175]
    v_mfma_f32_16x16x32_bf16 v[176:179], v[32:35], v[64:67], v[176:179]
    v_mfma_f32_16x16x32_bf16 v[180:183], v[32:35], v[68:71], v[180:183]
    v_mfma_f32_16x16x32_bf16 v[184:187], v[32:35], v[72:75], v[184:187]
    s_waitcnt lgkmcnt(9)
    v_mfma_f32_16x16x32_bf16 v[172:175], v[36:39], v[76:79], v[172:175]
    v_mfma_f32_16x16x32_bf16 v[176:179], v[36:39], v[80:83], v[176:179]
    v_mfma_f32_16x16x32_bf16 v[180:183], v[36:39], v[84:87], v[180:183]
    v_mfma_f32_16x16x32_bf16 v[184:187], v[36:39], v[88:91], v[184:187]
    s_waitcnt lgkmcnt(1)
    v_mfma_f32_16x16x32_bf16 v[172:175], v[40:43], v[92:95], v[172:175]
    v_mfma_f32_16x16x32_bf16 v[176:179], v[40:43], v[96:99], v[176:179]
    v_mfma_f32_16x16x32_bf16 v[180:183], v[40:43], v[100:103], v[180:183]
    v_mfma_f32_16x16x32_bf16 v[184:187], v[40:43], v[104:107], v[184:187]
    s_nop 4
    v_cvt_pk_bf16_f32 v196, v172, v173
    v_cvt_pk_bf16_f32 v198, v176, v177
    v_cvt_pk_bf16_f32 v200, v180, v181
    v_cvt_pk_bf16_f32 v202, v184, v185
    v_permlane16_swap_b32 v196, v198
    s_nop 0
    v_permlane16_swap_b32 v200, v202
    s_nop 1
    v_permlane32_swap_b32 v196, v200
    buffer_store_dwordx2 v[196:197], v4, s[16:19], s39 offen sc1
L_h_m1:
    v_lshrrev_b32 v4, 5, v1
    v_and_b32 v5, 31, v1
    v_lshlrev_b32 v5, 4, v5
    v_lshl_or_b32 v221, v4, 11, v5
    s_lshl_b32 s39, s35, 12
    s_add_u32 s39, s39, 4096
    s_add_u32 s40, s39, 16384

    s_waitcnt vmcnt(0)
L_spin7:
    ds_read_b32 v5, v211 offset:36
    s_waitcnt lgkmcnt(0)
    v_cmp_eq_u32 vcc, 0, v5
    s_cbranch_vccz L_spin7_ok
    s_sleep 1
    s_branch L_spin7
L_spin7_ok:
    buffer_load_dwordx4 v[44:47], v221, s[16:19], s39 offen offset:0 sc1
    buffer_load_dwordx4 v[60:63], v221, s[16:19], s40 offen offset:0 sc1
    buffer_load_dwordx4 v[48:51], v221, s[16:19], s39 offen offset:512 sc1
    buffer_load_dwordx4 v[64:67], v221, s[16:19], s40 offen offset:512 sc1
    buffer_load_dwordx4 v[52:55], v221, s[16:19], s39 offen offset:1024 sc1
    buffer_load_dwordx4 v[68:71], v221, s[16:19], s40 offen offset:1024 sc1
    buffer_load_dwordx4 v[56:59], v221, s[16:19], s39 offen offset:1536 sc1
    buffer_load_dwordx4 v[72:75], v221, s[16:19], s40 offen offset:1536 sc1
    s_lshl_b32 s56, s35, 6
    v_and_b32 v4, 60, v1
    v_add_u32 v4, s56, v4
    ds_bpermute_b32 v172, v4, v12
    ds_bpermute_b32 v173, v4, v13
    ds_bpermute_b32 v174, v4, v14
    ds_bpermute_b32 v175, v4, v15
    ds_bpermute_b32 v176, v4, v16
    ds_bpermute_b32 v177, v4, v17
    ds_bpermute_b32 v178, v4, v18
    ds_bpermute_b32 v179, v4, v19
    v_lshlrev_b32 v76, 16, v12
    v_and_b32 v77, 0xffff0000, v12
    v_lshlrev_b32 v78, 16, v13
    v_and_b32 v79, 0xffff0000, v13
    v_lshlrev_b32 v80, 16, v14
    v_and_b32 v81, 0xffff0000, v14
    v_lshlrev_b32 v82, 16, v15
    v_and_b32 v83, 0xffff0000, v15
    v_lshlrev_b32 v84, 16, v16
    v_and_b32 v85, 0xffff0000, v16
    v_lshlrev_b32 v86, 16, v17
    v_and_b32 v87, 0xffff0000, v17
    v_lshlrev_b32 v88, 16, v18
    v_and_b32 v89, 0xffff0000, v18
    v_lshlrev_b32 v90, 16, v19
    v_and_b32 v91, 0xffff0000, v19
    v_add_f32 v192, v76, v77
    v_add_f32 v192, v192, v78
    v_add_f32 v192, v192, v79
    v_add_f32 v192, v192, v80
    v_add_f32 v192, v192, v81
    v_add_f32 v192, v192, v82
    v_add_f32 v192, v192, v83
    v_add_f32 v193, v84, v85
    v_add_f32 v193, v193, v86
    v_add_f32 v193, v193, v87
    v_add_f32 v193, v193, v88
    v_add_f32 v193, v193, v89
    v_add_f32 v193, v193, v90
    v_add_f32 v193, v193, v91
    v_add_f32_dpp v192, v192, v192 quad_perm:[1,0,3,2] row_mask:0xf bank_mask:0xf bound_ctrl:1
    s_nop 0
    v_add_f32_dpp v193, v193, v193 quad_perm:[1,0,3,2] row_mask:0xf bank_mask:0xf bound_ctrl:1
    v_add_f32_dpp v192, v192, v192 quad_perm:[2,3,0,1] row_mask:0xf bank_mask:0xf bound_ctrl:1
    s_nop 0
    v_add_f32_dpp v193, v193, v193 quad_perm:[2,3,0,1] row_mask:0xf bank_mask:0xf bound_ctrl:1
    v_add_f32_dpp v192, v192, v192 row_half_mirror row_mask:0xf bank_mask:0xf bound_ctrl:1
    s_nop 0
    v_add_f32_dpp v193, v193, v193 row_half_mirror row_mask:0xf bank_mask:0xf bound_ctrl:1
    v_add_f32_dpp v192, v192, v192 row_mirror row_mask:0xf bank_mask:0xf bound_ctrl:1
    s_nop 0
    v_add_f32_dpp v193, v193, v193 row_mirror row_mask:0xf bank_mask:0xf bound_ctrl:1
    v_mov_b32 v196, v192
    v_mov_b32 v197, v193
    s_nop 0
    v_permlane16_swap_b32 v196, v192
    v_permlane16_swap_b32 v197, v193
    v_add_f32 v192, v192, v196
    v_add_f32 v193, v193, v197
    v_mov_b32 v196, v192
    v_mov_b32 v197, v193
    s_nop 0
    v_permlane32_swap_b32 v196, v192
    v_permlane32_swap_b32 v197, v193
    v_add_f32 v192, v192, v196
    v_add_f32 v193, v193, v197
    v_mul_f32 v192, 0x3b000000, v192
    v_mul_f32 v193, 0x3b000000, v193
    v_sub_f32 v76, v76, v192
    v_sub_f32 v77, v77, v192
    v_sub_f32 v78, v78, v192
    v_sub_f32 v79, v79, v192
    v_sub_f32 v80, v80, v192
    v_sub_f32 v81, v81, v192
    v_sub_f32 v82, v82, v192
    v_sub_f32 v83, v83, v192
    v_mul_f32 v194, v76, v76
    v_fmac_f32 v194, v77, v77
    v_fmac_f32 v194, v78, v78
    v_fmac_f32 v194, v79, v79
    v_fmac_f32 v194, v80, v80
    v_fmac_f32 v194, v81, v81
    v_fmac_f32 v194, v82, v82
    v_fmac_f32 v194, v83, v83
    v_sub_f32 v84, v84, v193
    v_sub_f32 v85, v85, v193
    v_sub_f32 v86, v86, v193
    v_sub_f32 v87, v87, v193
    v_sub_f32 v88, v88, v193
    v_sub_f32 v89, v89, v193
    v_sub_f32 v90, v90, v193
    v_sub_f32 v91, v91, v193
    v_mul_f32 v195, v84, v84
    v_fmac_f32 v195, v85, v85
    v_fmac_f32 v195, v86, v86
    v_fmac_f32 v195, v87, v87
    v_fmac_f32 v195, v88, v88
    v_fmac_f32 v195, v89, v89
    v_fmac_f32 v195, v90, v90
    v_fmac_f32 v195, v91, v91
    v_add_f32_dpp v194, v194, v194 quad_perm:[1,0,3,2] row_mask:0xf bank_mask:0xf bound_ctrl:1
    s_nop 0
    v_add_f32_dpp v195, v195, v195 quad_perm:[1,0,3,2] row_mask:0xf bank_mask:0xf bound_ctrl:1
    v_add_f32_dpp v194, v194, v194 quad_perm:[2,3,0,1] row_mask:0xf bank_mask:0xf bound_ctrl:1
    s_nop 0
    v_add_f32_dpp v195, v195, v195 quad_perm:[2,3,0,1] row_mask:0xf bank_mask:0xf bound_ctrl:1
    v_add_f32_dpp v194, v194, v194 row_half_mirror row_mask:0xf bank_mask:0xf bound_ctrl:1
    s_nop 0
    v_add_f32_dpp v195, v195, v195 row_half_mirror row_mask:0xf bank_mask:0xf bound_ctrl:1
    v_add_f32_dpp v194, v194, v194 row_mirror row_mask:0xf bank_mask:0xf bound_ctrl:1
    s_nop 0
    v_add_f32_dpp v195, v195, v195 row_mirror row_mask:0xf bank_mask:0xf bound_ctrl:1
    v_mov_b32 v196, v194
    v_mov_b32 v197, v195
    s_nop 0
    v_permlane16_swap_b32 v196, v194
    v_permlane16_swap_b32 v197, v195
    v_add_f32 v194, v194, v196
    v_add_f32 v195, v195, v197
    v_mov_b32 v196, v194
    v_mov_b32 v197, v195
    s_nop 0
    v_permlane32_swap_b32 v196, v194
    v_permlane32_swap_b32 v197, v195
    v_add_f32 v194, v194, v196
    v_add_f32 v195, v195, v197
    v_mov_b32 v196, 0x3727c5ac
    v_fmac_f32 v196, 0x3b000000, v194
    v_mov_b32 v197, 0x3727c5ac
    v_fmac_f32 v197, 0x3b000000, v195
    v_rsq_f32 v194, v196
    v_rsq_f32 v195, v197
    s_waitcnt lgkmcnt(0)
    v_and_b32 v4, 1, v1
    v_cmp_eq_u32 vcc, 1, v4
    s_nop 1
    v_cndmask_b32 v172, v172, v173, vcc
    v_cndmask_b32 v174, v174, v175, vcc
    v_cndmask_b32 v176, v176, v177, vcc
    v_cndmask_b32 v178, v178, v179, vcc
    v_and_b32 v4, 2, v1
    v_cmp_eq_u32 vcc, 2, v4
    s_nop 1
    v_cndmask_b32 v20, v172, v174, vcc
    v_cndmask_b32 v21, v176, v178, vcc
    v_lshlrev_b32 v214, 16, v20
    v_and_b32 v215, 0xffff0000, v20
    v_lshlrev_b32 v216, 16, v21
    v_and_b32 v217, 0xffff0000, v21
    v_sub_f32 v214, v214, v192
    v_mul_f32 v214, v214, v194
    v_sub_f32 v215, v215, v192
    v_mul_f32 v215, v215, v194
    v_sub_f32 v216, v216, v193
    v_mul_f32 v216, v216, v195
    v_sub_f32 v217, v217, v193
    v_mul_f32 v217, v217, v195
L_spin8:
    ds_read_b32 v5, v211 offset:4
    s_waitcnt lgkmcnt(0)
    v_cmp_eq_u32 vcc, 0, v5
    s_cbranch_vccnz L_spin8
    ds_read_b64_tr_b16 v[108:109], v22 offset:32768
    ds_read_b64_tr_b16 v[110:111], v22 offset:34816
    ds_read_b64_tr_b16 v[112:113], v23 offset:32768
    ds_read_b64_tr_b16 v[114:115], v23 offset:34816
    ds_read_b64_tr_b16 v[116:117], v24 offset:32768
    ds_read_b64_tr_b16 v[118:119], v24 offset:34816
    ds_read_b64_tr_b16 v[120:121], v25 offset:32768
    ds_read_b64_tr_b16 v[122:123], v25 offset:34816
    ds_read_b64_tr_b16 v[124:125], v22 offset:36864
    ds_read_b64_tr_b16 v[126:127], v22 offset:38912
    ds_read_b64_tr_b16 v[128:129], v23 offset:36864
    ds_read_b64_tr_b16 v[130:131], v23 offset:38912
    ds_read_b64_tr_b16 v[132:133], v24 offset:36864
    ds_read_b64_tr_b16 v[134:135], v24 offset:38912
    ds_read_b64_tr_b16 v[136:137], v25 offset:36864
    ds_read_b64_tr_b16 v[138:139], v25 offset:38912
    ds_read_b64_tr_b16 v[140:141], v22 offset:40960
    ds_read_b64_tr_b16 v[142:143], v22 offset:43008
    ds_read_b64_tr_b16 v[144:145], v23 offset:40960
    ds_read_b64_tr_b16 v[146:147], v23 offset:43008
    ds_read_b64_tr_b16 v[148:149], v24 offset:40960
    ds_read_b64_tr_b16 v[150:151], v24 offset:43008
    ds_read_b64_tr_b16 v[152:153], v25 offset:40960
    ds_read_b64_tr_b16 v[154:155], v25 offset:43008
    ds_read_b64_tr_b16 v[156:157], v22 offset:45056
    ds_read_b64_tr_b16 v[158:159], v22 offset:47104
    ds_read_b64_tr_b16 v[160:161], v23 offset:45056
    ds_read_b64_tr_b16 v[162:163], v23 offset:47104
    ds_read_b64_tr_b16 v[164:165], v24 offset:45056
    ds_read_b64_tr_b16 v[166:167], v24 offset:47104
    ds_read_b64_tr_b16 v[168:169], v25 offset:45056
    ds_read_b64_tr_b16 v[170:171], v25 offset:47104
    v_bfe_u32 v4, v1, 1, 2
    v_lshlrev_b32 v4, 4, v4
    v_and_b32 v5, 8, v1
    v_or_b32 v4, v4, v5
    v_and_b32 v5, 1, v1
    v_lshl_or_b32 v4, v5, 2, v4
    v_lshl_or_b32 v4, v2, 6, v4
    v_add_u32 v218, 131584, v4
    v_bfe_u32 v5, v1, 2, 1
    v_lshlrev_b32 v5, 8, v5
    v_lshl_or_b32 v5, v2, 4, v5
    v_add_u32 v219, 131584, v5
    s_mov_b32 s58, s32
    s_add_u32 s57, s58, 262144
    v_lshlrev_b32 v4, 14, v2
    v_lshl_or_b32 v222, v3, 4, v4
    s_lshr_b32 s56, s37, 1
    s_and_b32 s42, s37, 1
    s_lshl_b32 s41, s56, 11
    s_lshl_b32 s59, s42, 8
    s_add_u32 s41, s41, s59
    s_add_u32 s41, s41, 36864
    v_mov_b32 v189, s92
    v_mov_b32 v191, s92
    s_waitcnt vmcnt(0)
    v_xor_b32 v209, s43, v45
    v_bitop3_b32 v209, v47, s43, v209 bitop3:0xbe
    v_bitop3_b32 v209, v49, s43, v209 bitop3:0xbe
    v_bitop3_b32 v209, v51, s43, v209 bitop3:0xbe
    v_bitop3_b32 v209, v53, s43, v209 bitop3:0xbe
    v_bitop3_b32 v209, v55, s43, v209 bitop3:0xbe
    v_bitop3_b32 v209, v57, s43, v209 bitop3:0xbe
    v_bitop3_b32 v209, v59, s43, v209 bitop3:0xbe
    v_bitop3_b32 v209, v61, s43, v209 bitop3:0xbe
    v_bitop3_b32 v209, v63, s43, v209 bitop3:0xbe
    v_bitop3_b32 v209, v65, s43, v209 bitop3:0xbe
    v_bitop3_b32 v209, v67, s43, v209 bitop3:0xbe
    v_bitop3_b32 v209, v69, s43, v209 bitop3:0xbe
    v_bitop3_b32 v209, v71, s43, v209 bitop3:0xbe
    v_bitop3_b32 v209, v73, s43, v209 bitop3:0xbe
    v_bitop3_b32 v209, v75, s43, v209 bitop3:0xbe
    v_cmp_ne_u32 vcc, 0, v209
    s_cbranch_vccnz L_h_p1_re
L_h_p1_ok:

    v_dot2_f32_bf16 v196, v44, s95, 0
    v_dot2_f32_bf16 v197, v44, s93, 0
    v_dot2_f32_bf16 v198, v46, s95, 0
    v_dot2_f32_bf16 v199, v46, s93, 0
    v_dot2_f32_bf16 v196, v48, s95, v196
    v_dot2_f32_bf16 v197, v48, s93, v197
    v_dot2_f32_bf16 v198, v50, s95, v198
    v_dot2_f32_bf16 v199, v50, s93, v199
    v_dot2_f32_bf16 v196, v52, s95, v196
    v_dot2_f32_bf16 v197, v52, s93, v197
    v_dot2_f32_bf16 v198, v54, s95, v198
    v_dot2_f32_bf16 v199, v54, s93, v199
    v_dot2_f32_bf16 v196, v56, s95, v196
    v_dot2_f32_bf16 v197, v56, s93, v197
    v_dot2_f32_bf16 v198, v58, s95, v198
    v_dot2_f32_bf16 v199, v58, s93, v199
    v_dot2_f32_bf16 v200, v60, s95, 0
    v_dot2_f32_bf16 v201, v60, s93, 0
    v_dot2_f32_bf16 v202, v62, s95, 0
    v_dot2_f32_bf16 v203, v62, s93, 0
    v_dot2_f32_bf16 v200, v64, s95, v200
    v_dot2_f32_bf16 v201, v64, s93, v201
    v_dot2_f32_bf16 v202, v66, s95, v202
    v_dot2_f32_bf16 v203, v66, s93, v203
    v_dot2_f32_bf16 v200, v68, s95, v200
    v_dot2_f32_bf16 v201, v68, s93, v201
    v_dot2_f32_bf16 v202, v70, s95, v202
    v_dot2_f32_bf16 v203, v70, s93, v203
    v_dot2_f32_bf16 v200, v72, s95, v200
    v_dot2_f32_bf16 v201, v72, s93, v201
    v_dot2_f32_bf16 v202, v74, s95, v202
    v_dot2_f32_bf16 v203, v74, s93, v203
    v_add_f32 v200, 1.0, v200
    v_fmac_f32 v196, v214, v200
    v_add_f32 v201, 1.0, v201
    v_fmac_f32 v197, v216, v201
    v_add_f32 v202, 1.0, v202
    v_fmac_f32 v198, v215, v202
    v_add_f32 v203, 1.0, v203
    v_fmac_f32 v199, v217, v203
    v_cvt_pk_bf16_f32 v204, v196, v198
    v_cvt_pk_bf16_f32 v205, v197, v199
    ds_write_b32 v218, v204
    ds_write_b32 v218, v205 offset:256
    ds_read_b128 v[28:31], v219 offset:0
    ds_read_b128 v[32:35], v219 offset:64
    ds_read_b128 v[36:39], v219 offset:128
    ds_read_b128 v[40:43], v219 offset:192
    s_waitcnt lgkmcnt(3)
    v_mfma_f32_16x16x32_bf16 v[172:175], v[28:31], v[108:111], 0
    v_mfma_f32_16x16x32_bf16 v[176:179], v[28:31], v[112:115], 0
    v_mfma_f32_16x16x32_bf16 v[180:183], v[28:31], v[116:119], 0
    v_mfma_f32_16x16x32_bf16 v[184:187], v[28:31], v[120:123], 0
    s_waitcnt lgkmcnt(2)
    v_mfma_f32_16x16x32_bf16 v[172:175], v[32:35], v[124:127], v[172:175]
    v_mfma_f32_16x16x32_bf16 v[176:179], v[32:35], v[128:131], v[176:179]
    v_mfma_f32_16x16x32_bf16 v[180:183], v[32:35], v[132:135], v[180:183]
    v_mfma_f32_16x16x32_bf16 v[184:187], v[32:35], v[136:139], v[184:187]
    s_waitcnt lgkmcnt(1)
    v_mfma_f32_16x16x32_bf16 v[172:175], v[36:39], v[140:143], v[172:175]
    v_mfma_f32_16x16x32_bf16 v[176:179], v[36:39], v[144:147], v[176:179]
    v_mfma_f32_16x16x32_bf16 v[180:183], v[36:39], v[148:151], v[180:183]
    v_mfma_f32_16x16x32_bf16 v[184:187], v[36:39], v[152:155], v[184:187]
    s_waitcnt lgkmcnt(0)
    v_mfma_f32_16x16x32_bf16 v[172:175], v[40:43], v[156:159], v[172:175]
    v_mfma_f32_16x16x32_bf16 v[176:179], v[40:43], v[160:163], v[176:179]
    v_mfma_f32_16x16x32_bf16 v[180:183], v[40:43], v[164:167], v[180:183]
    v_mfma_f32_16x16x32_bf16 v[184:187], v[40:43], v[168:171], v[184:187]
    v_mov_b32 v5, s43
    ds_write_b32 v211, v5 offset:3328
    s_nop 2
    v_mov_b32 v188, v172
    s_nop 0
    v_mov_b32 v190, v180
    v_mov_b32_dpp v188, v176 quad_perm:[0,1,2,3] row_mask:0xc bank_mask:0xf
    s_nop 0
    v_mov_b32_dpp v190, v184 quad_perm:[0,1,2,3] row_mask:0xc bank_mask:0xf
    v_mov_b32_dpp v196, v188 quad_perm:[1,0,3,2] row_mask:0xf bank_mask:0xf bound_ctrl:1
    s_nop 0
    v_mov_b32_dpp v197, v190 quad_perm:[1,0,3,2] row_mask:0xf bank_mask:0xf bound_ctrl:1
    v_cvt_pk_bf16_f32 v188, v188, v196
    v_cvt_pk_bf16_f32 v190, v197, v190
    v_cndmask_b32 v188, v188, v190, s[48:49]
    buffer_store_dwordx2 v[188:189], v220, s[16:19], s58 offen
    ds_write_b32 v211, v212 offset:12
    buffer_store_dwordx2 v[188:189], v220, s[16:19], s57 offen sc1
    s_cmp_ge_u32 s37, 16
    s_cbranch_scc1 L_h_end

    buffer_load_dwordx4 v[28:31], v222, s[16:19], s41 offen offset:0 sc1
    buffer_load_dwordx4 v[32:35], v222, s[16:19], s41 offen offset:512 sc1
    buffer_load_dwordx4 v[36:39], v222, s[16:19], s41 offen offset:1024 sc1
    buffer_load_dwordx4 v[40:43], v222, s[16:19], s41 offen offset:1536 sc1
    v_cmp_eq_u32 vcc, 2, v2
    s_nop 1
    v_cndmask_b32 v6, 0, 1.0, vcc
    v_lshlrev_b32 v4, 8, v2
    v_lshl_or_b32 v4, v3, 3, v4
    v_add_u32 v7, 133376, v4
    v_bfe_u32 v4, v3, 1, 2
    v_lshlrev_b32 v4, 6, v4
    v_and_b32 v5, 8, v3
    v_or_b32 v4, v4, v5
    v_and_b32 v5, 1, v3
    v_lshl_or_b32 v4, v5, 2, v4
    v_and_b32 v5, 1, v2
    v_lshl_or_b32 v4, v5, 4, v4
    s_mul_i32 s39, s36, 8448
    s_lshl_b32 s59, s37, 9
    s_add_u32 s39, s39, s59
    s_add_u32 s39, s39, 1196032
    s_waitcnt vmcnt(0)
    v_xor_b32 v209, s43, v29
    v_bitop3_b32 v209, v31, s43, v209 bitop3:0xbe
    v_bitop3_b32 v209, v33, s43, v209 bitop3:0xbe
    v_bitop3_b32 v209, v35, s43, v209 bitop3:0xbe
    v_bitop3_b32 v209, v37, s43, v209 bitop3:0xbe
    v_bitop3_b32 v209, v39, s43, v209 bitop3:0xbe
    v_bitop3_b32 v209, v41, s43, v209 bitop3:0xbe
    v_bitop3_b32 v209, v43, s43, v209 bitop3:0xbe
    v_cmp_ne_u32 vcc, 0, v209
    s_cbranch_vccnz L_h_p2_re
L_h_p2_ok:
    v_dot2_f32_bf16 v196, v28, s95, 0
    v_dot2_f32_bf16 v197, v28, s93, 0
    v_dot2_f32_bf16 v198, v30, s95, 0
    v_dot2_f32_bf16 v199, v30, s93, 0
    v_dot2_f32_bf16 v196, v32, s95, v196
    v_dot2_f32_bf16 v197, v32, s93, v197
    v_dot2_f32_bf16 v198, v34, s95, v198
    v_dot2_f32_bf16 v199, v34, s93, v199
    v_dot2_f32_bf16 v196, v36, s95, v196
    v_dot2_f32_bf16 v197, v36, s93, v197
    v_dot2_f32_bf16 v198, v38, s95, v198
    v_dot2_f32_bf16 v199, v38, s93, v199
    v_dot2_f32_bf16 v196, v40, s95, v196
    v_dot2_f32_bf16 v197, v40, s93, v197
    v_dot2_f32_bf16 v198, v42, s95, v198
    v_dot2_f32_bf16 v199, v42, s93, v199
    s_nop 1
    v_cvt_pk_bf16_f32 v200, v196, v198
    v_cvt_pk_bf16_f32 v201, v197, v199
    v_lshlrev_b32 v196, 16, v200
    v_and_b32 v198, 0xffff0000, v200
    v_lshlrev_b32 v197, 16, v201
    v_and_b32 v199, 0xffff0000, v201
    v_add_f32 v196, v196, v6
    v_add_f32 v197, v197, v6
    v_add_f32 v198, v198, v6
    v_add_f32 v199, v199, v6
    v_cvt_pk_bf16_f32 v200, v196, v198
    v_cvt_pk_bf16_f32 v201, v197, v199
    v_lshlrev_b32 v196, 16, v200
    v_and_b32 v198, 0xffff0000, v200
    v_lshlrev_b32 v197, 16, v201
    v_and_b32 v199, 0xffff0000, v201
    v_mov_b32 v202, v196
    v_mov_b32 v203, v198
    v_mov_b32 v204, v197
    v_mov_b32 v205, v199
    ds_write_b64 v7, v[202:203]
    ds_write_b64 v7, v[204:205] offset:128
L_spin9:
    ds_read_b128 v[172:175], v211 offset:48
    s_waitcnt lgkmcnt(0)
    v_min3_u32 v176, v172, v173, v174
    v_min_u32 v176, v176, v175
    v_cmp_eq_u32 vcc, 0, v176
    s_cbranch_vccz L_spin9_ok
    s_sleep 1
    s_branch L_spin9
L_spin9_ok:
    v_max3_u32 v172, v172, v173, v174
    v_max_u32 v172, v172, v175
    v_cmp_lt_u32 vcc, 1, v172
    s_cbranch_vccnz L_h_cprem
    s_mov_b32 exec_lo, 0xffff0000
    s_mov_b32 exec_hi, 0xffff
    buffer_store_dword v200, v4, s[16:19], s39 offen offset:256
    buffer_store_dword v201, v4, s[16:19], s39 offen offset:288
L_h_end:
    s_waitcnt lgkmcnt(0)
    s_endpgm
L_h_cprem:
    s_add_u32 s39, s39, 81920
    s_mov_b32 exec_lo, 0xffff0000
    s_mov_b32 exec_hi, 0xffff
    buffer_store_dword v200, v4, s[16:19], s39 offen offset:256 sc1
    buffer_store_dword v201, v4, s[16:19], s39 offen offset:288 sc1
    s_lshl_b32 s39, s36, 7
    s_lshl_b32 s59, s37, 2
    s_add_u32 s39, s39, s59
    s_add_u32 s39, s39, 1368064
    s_waitcnt vmcnt(0)
    s_mov_b64 exec, 1
    v_mov_b32 v196, 0
    v_mov_b32 v197, s43
    buffer_store_dword v197, v196, s[16:19], s39 offen sc1
    s_mov_b64 exec, -1
    s_branch L_h_end
L_h_p1_re:
    s_mov_b32 s44, 0
L_h_p1_re2:
    buffer_load_dwordx4 v[44:47], v221, s[16:19], s39 offen offset:0 sc1
    buffer_load_dwordx4 v[60:63], v221, s[16:19], s40 offen offset:0 sc1
    buffer_load_dwordx4 v[48:51], v221, s[16:19], s39 offen offset:512 sc1
    buffer_load_dwordx4 v[64:67], v221, s[16:19], s40 offen offset:512 sc1
    buffer_load_dwordx4 v[52:55], v221, s[16:19], s39 offen offset:1024 sc1
    buffer_load_dwordx4 v[68:71], v221, s[16:19], s40 offen offset:1024 sc1
    buffer_load_dwordx4 v[56:59], v221, s[16:19], s39 offen offset:1536 sc1
    buffer_load_dwordx4 v[72:75], v221, s[16:19], s40 offen offset:1536 sc1
    s_add_u32 s44, s44, 1
    s_cmp_gt_u32 s44, 100000
    s_waitcnt vmcnt(0)
    s_cbranch_scc1 L_h_p1_ok
    v_xor_b32 v209, s43, v45
    v_bitop3_b32 v209, v47, s43, v209 bitop3:0xbe
    v_bitop3_b32 v209, v49, s43, v209 bitop3:0xbe
    v_bitop3_b32 v209, v51, s43, v209 bitop3:0xbe
    v_bitop3_b32 v209, v53, s43, v209 bitop3:0xbe
    v_bitop3_b32 v209, v55, s43, v209 bitop3:0xbe
    v_bitop3_b32 v209, v57, s43, v209 bitop3:0xbe
    v_bitop3_b32 v209, v59, s43, v209 bitop3:0xbe
    v_bitop3_b32 v209, v61, s43, v209 bitop3:0xbe
    v_bitop3_b32 v209, v63, s43, v209 bitop3:0xbe
    v_bitop3_b32 v209, v65, s43, v209 bitop3:0xbe
    v_bitop3_b32 v209, v67, s43, v209 bitop3:0xbe
    v_bitop3_b32 v209, v69, s43, v209 bitop3:0xbe
    v_bitop3_b32 v209, v71, s43, v209 bitop3:0xbe
    v_bitop3_b32 v209, v73, s43, v209 bitop3:0xbe
    v_bitop3_b32 v209, v75, s43, v209 bitop3:0xbe
    v_cmp_ne_u32 vcc, 0, v209
    s_cbranch_vccnz L_h_p1_re2
    s_branch L_h_p1_ok
L_h_p2_re:
    s_mov_b32 s44, 0
L_h_p2_re2:
    buffer_load_dwordx4 v[28:31], v222, s[16:19], s41 offen offset:0 sc1
    buffer_load_dwordx4 v[32:35], v222, s[16:19], s41 offen offset:512 sc1
    buffer_load_dwordx4 v[36:39], v222, s[16:19], s41 offen offset:1024 sc1
    buffer_load_dwordx4 v[40:43], v222, s[16:19], s41 offen offset:1536 sc1
    s_add_u32 s44, s44, 1
    s_cmp_gt_u32 s44, 100000
    s_waitcnt vmcnt(0)
    s_cbranch_scc1 L_h_p2_ok
    v_xor_b32 v209, s43, v29
    v_bitop3_b32 v209, v31, s43, v209 bitop3:0xbe
    v_bitop3_b32 v209, v33, s43, v209 bitop3:0xbe
    v_bitop3_b32 v209, v35, s43, v209 bitop3:0xbe
    v_bitop3_b32 v209, v37, s43, v209 bitop3:0xbe
    v_bitop3_b32 v209, v39, s43, v209 bitop3:0xbe
    v_bitop3_b32 v209, v41, s43, v209 bitop3:0xbe
    v_bitop3_b32 v209, v43, s43, v209 bitop3:0xbe
    v_cmp_ne_u32 vcc, 0, v209
    s_cbranch_vccnz L_h_p2_re2
    s_branch L_h_p2_ok

L_compute:
    s_sub_u32 s47, s3, 2
    s_waitcnt lgkmcnt(0)
    s_barrier
    s_load_dwordx2 s[32:33], s[0:1], 80
    v_mov_b32 v8, 131072
    v_mov_b32 v12, 1
    s_lshl_b32 s39, s47, 2
    v_add_u32 v11, s39, v8
    v_and_b32 v9, 3, v3
    v_and_b32 v10, 3, v1
    v_lshlrev_b32 v29, 4, v1
    v_xor_b32 v4, v2, v3
    v_lshlrev_b32 v4, 4, v4
    v_lshl_or_b32 v4, v3, 8, v4
    s_lshl_b32 s39, s47, 14
    v_add_u32 v14, s39, v4
    v_xor_b32 v15, 64, v14
    v_xor_b32 v16, 128, v14
    v_xor_b32 v17, 192, v14
    v_mul_u32_u24 v4, 288, v9
    v_lshl_add_u32 v4, v2, 4, v4
    v_add_u32 v18, 132096, v4
    v_lshrrev_b32 v4, 2, v1
    v_and_b32 v5, 7, v4
    v_lshlrev_b32 v5, 5, v5
    v_lshl_or_b32 v4, v4, 8, v5
    v_lshl_or_b32 v22, v10, 3, v4
    s_lshl_b32 s39, s47, 6
    v_xor_b32 v4, s39, v22
    v_add_u32 v20, 65536, v4
    v_xor_b32 v21, 32, v20
    v_lshlrev_b32 v4, 5, v9
    v_add_u32 v24, 131136, v4
    s_lshl_b32 s39, s47, 3
    v_add_u32 v23, s39, v24
    v_lshlrev_b32 v4, 6, v2
    v_lshl_or_b32 v4, v9, 4, v4
    v_add_u32 v26, 134656, v4
    v_lshrrev_b32 v4, 3, v3
    v_bfe_u32 v5, v3, 2, 1
    v_lshlrev_b32 v5, 3, v5
    v_lshl_or_b32 v4, v4, 8, v5
    s_lshl_b32 s39, s47, 9
    v_add3_u32 v25, v4, s39, v26
    v_lshlrev_b32 v27, 12, v9
    v_lshl_or_b32 v27, v2, 8, v27
    v_lshlrev_b32 v28, 7, v9
    s_mul_i32 s57, s47, 288
    s_add_u32 s57, s57, 132096
    v_and_b32 v4, 31, v1
    v_lshrrev_b32 v5, 5, v1
    v_lshlrev_b32 v31, 4, v4
    v_lshl_or_b32 v31, v5, 11, v31
    v_lshl_or_b32 v4, v4, 1, v5
    v_lshl_add_u32 v30, v4, 2, s57
    v_cmp_gt_u32 s[48:49], 4, v3
    s_cmp_eq_u32 s47, 0
    s_cselect_b64 s[50:51], 15, 0
    s_lshl_b32 s4, s36, 15
    s_lshl_b32 s59, s45, 14
    s_add_u32 s4, s4, s59
    s_lshl_b32 s59, s47, 10
    s_add_u32 s4, s4, s59
    s_lshl_b32 s59, s46, 4
    s_add_u32 s4, s4, s59
    s_add_u32 s4, s4, 655360
    s_lshl_b32 s5, s36, 10
    s_lshl_b32 s59, s45, 9
    s_add_u32 s5, s5, s59
    s_lshl_b32 s59, s46, 3
    s_add_u32 s5, s5, s59
    s_add_u32 s5, s5, 1179648
    s_mov_b32 s6, 0x3e0293ee
    s_mov_b32 s95, 0x3f80
    s_mov_b32 s93, 0x3f800000
    s_getreg_b32 s92, hwreg(HW_REG_XCC_ID, 0, 3)
    s_mov_b32 s18, 1769472
    s_mov_b32 s19, 0x20000
    s_mov_b32 s30, 2048
    s_mov_b32 s31, 0x20000
    s_mov_b32 s34, 2048
    s_mov_b32 s35, 0x20000
    v_mov_b32 v184, 0
    v_mov_b32 v185, 0
    v_mov_b32 v186, 0
    v_mov_b32 v187, 0
    v_mov_b32 v188, 0
    v_mov_b32 v189, 0
    v_mov_b32 v190, 0
    v_mov_b32 v191, 0
    v_mov_b32 v192, 0
    v_mov_b32 v193, 0
    v_mov_b32 v194, 0
    v_mov_b32 v195, 0
    s_waitcnt lgkmcnt(0)
    s_cmp_lt_u32 s37, 16
    s_cbranch_scc0 L_c_nt1
    s_and_b32 s54, s47, 1
    s_lshr_b32 s39, s47, 1
    s_lshr_b32 s40, s37, 2
    s_and_b32 s41, s37, 3
    v_lshlrev_b32 v184, 5, v2
    v_lshl_or_b32 v184, v9, 3, v184
    s_lshl_b32 s7, s36, 15
    s_lshl_b32 s59, s54, 14
    s_add_u32 s7, s7, s59
    s_lshl_b32 s59, s40, 12
    s_add_u32 s7, s7, s59
    s_add_u32 s7, s7, 655360
    s_lshl_b32 s8, s36, 10
    s_lshl_b32 s59, s54, 9
    s_add_u32 s8, s8, s59
    s_lshl_b32 s59, s40, 7
    s_add_u32 s8, s8, s59
    s_add_u32 s8, s8, 1179648
    v_and_b32 v4, 7, v1
    v_lshl_or_b32 v186, v4, 2, v2
    v_lshlrev_b32 v195, 1, v186
    s_lshl_b32 s14, s54, 10
    s_lshl_b32 s59, s37, 6
    s_add_u32 s14, s14, s59
    s_lshl_b32 s42, s39, 7
    v_xor_b32 v196, s42, v22
    v_xor_b32 v197, 32, v196
    v_xor_b32 v198, 64, v196
    v_xor_b32 v199, 96, v196
    v_lshrrev_b32 v4, 5, v1
    v_and_b32 v5, 30, v1
    v_lshlrev_b32 v5, 2, v5
    v_lshl_or_b32 v187, v4, 13, v5
    s_lshl_b32 s9, s41, 15
    s_lshl_b32 s59, s39, 14
    s_add_u32 s9, s9, s59
    s_lshl_b32 s59, s54, 12
    s_add_u32 s9, s9, s59
    s_lshl_b32 s59, s36, 9
    s_add_u32 s9, s9, s59
    s_lshl_b32 s59, s40, 7
    s_add_u32 s9, s9, s59
    s_add_u32 s9, s9, 1376256
    s_lshl_b32 s10, s37, 13
    s_lshl_b32 s59, s54, 12
    s_add_u32 s10, s10, s59
    s_add_u32 s10, s10, 1376256
    v_lshlrev_b32 v4, 6, v10
    v_bfe_u32 v5, v1, 2, 1
    v_lshl_or_b32 v4, v5, 3, v4
    v_and_b32 v5, 1, v2
    v_lshl_or_b32 v4, v5, 4, v4
    v_lshrrev_b32 v5, 1, v2
    v_lshl_or_b32 v192, v5, 2, v4
    v_lshrrev_b32 v193, 1, v1
    s_mul_i32 s11, s36, 8448
    s_lshl_b32 s59, s37, 9
    s_add_u32 s11, s11, s59
    s_lshl_b32 s59, s54, 5
    s_add_u32 s11, s11, s59
    s_add_u32 s11, s11, 1196032
    s_mul_i32 s12, s36, 8448
    s_lshl_b32 s59, s37, 4
    s_add_u32 s12, s12, s59
    s_lshl_b32 s59, s54, 3
    s_add_u32 s12, s12, s59
    s_add_u32 s12, s12, 1204224
    s_lshl_b32 s56, s37, 1
    s_add_u32 s15, s56, s54
    s_mul_i32 s13, s15, 7168
    s_add_u32 s13, s13, 1507328
    s_add_u32 s26, s13, 4096
    s_sub_u32 s55, s36, s56
    s_and_b32 s55, s55, 7
    s_lshl_b32 s56, s54, 7
    s_add_u32 s56, s56, 133376
    v_lshl_add_u32 v194, v186, 2, s56
    s_cmp_eq_u32 s47, 1
    s_cbranch_scc0 L_c_roledone
    s_load_dwordx2 s[20:21], s[0:1], 64
    s_lshr_b32 s24, s2, 2
    s_add_u32 s24, s24, 16
    s_and_b32 s25, s2, 3
    v_and_b32 v4, 1, v3
    v_lshlrev_b32 v4, 10, v4
    v_lshrrev_b32 v5, 1, v3
    v_lshl_or_b32 v4, v5, 5, v4
    v_lshl_or_b32 v4, v2, 3, v4
    v_mov_b32 v5, 0
    s_lshl_b32 s39, s25, 8
    s_mov_b32 s22, 2048
    s_mov_b32 s23, 0x20000
    s_waitcnt lgkmcnt(0)
    buffer_load_dword v178, v5, s[16:19], 0 offen sc1
    buffer_load_dwordx2 v[176:177], v4, s[20:23], s39 offen
    v_lshrrev_b32 v4, 2, v1
    v_bfe_u32 v5, v1, 3, 2
    v_lshlrev_b32 v5, 5, v5
    v_lshl_or_b32 v4, v4, 7, v5
    v_and_b32 v5, 3, v1
    v_lshl_or_b32 v4, v5, 3, v4
    v_add_u32 v180, 98304, v4
    v_xor_b32 v181, 32, v180
    v_xor_b32 v182, 64, v180
    v_xor_b32 v183, 96, v180
    s_waitcnt vmcnt(0)
    v_readfirstlane_b32 s43, v178
    s_nop 0
    s_add_u32 s43, s43, 0x9E3779B1
    v_lshlrev_b32 v36, 16, v176
    v_and_b32 v37, 0xffff0000, v176
    v_lshlrev_b32 v38, 16, v177
    v_and_b32 v39, 0xffff0000, v177
    v_mul_f32 v40, 0xbfb8aa3b, v36
    v_mul_f32 v41, 0xbfb8aa3b, v37
    v_mul_f32 v42, 0xbfb8aa3b, v38
    v_mul_f32 v43, 0xbfb8aa3b, v39
    v_exp_f32 v40, v40
    v_exp_f32 v41, v41
    v_exp_f32 v42, v42
    v_exp_f32 v43, v43
    v_add_f32 v40, 1.0, v40
    v_add_f32 v41, 1.0, v41
    v_add_f32 v42, 1.0, v42
    v_add_f32 v43, 1.0, v43
    v_rcp_f32 v40, v40
    v_rcp_f32 v41, v41
    v_rcp_f32 v42, v42
    v_rcp_f32 v43, v43
    v_mul_f32 v36, v36, v40
    v_mul_f32 v37, v37, v41
    v_mul_f32 v38, v38, v42
    v_mul_f32 v39, v39, v43
    v_cvt_pk_bf16_f32 v128, v36, v37
    v_cvt_pk_bf16_f32 v129, v38, v39
    s_nop 0
    v_mov_b32_dpp v130, v128 row_shl:2 row_mask:0xf bank_mask:0xf bound_ctrl:1
    v_mov_b32_dpp v131, v129 row_shl:2 row_mask:0xf bank_mask:0xf bound_ctrl:1
    v_mov_b32_dpp v132, v128 row_shl:4 row_mask:0xf bank_mask:0xf bound_ctrl:1
    v_mov_b32_dpp v133, v129 row_shl:4 row_mask:0xf bank_mask:0xf bound_ctrl:1
    v_mov_b32_dpp v134, v128 row_shl:6 row_mask:0xf bank_mask:0xf bound_ctrl:1
    v_mov_b32_dpp v135, v129 row_shl:6 row_mask:0xf bank_mask:0xf bound_ctrl:1
    v_mov_b32_dpp v136, v128 row_shl:8 row_mask:0xf bank_mask:0xf bound_ctrl:1
    v_mov_b32_dpp v137, v129 row_shl:8 row_mask:0xf bank_mask:0xf bound_ctrl:1
    v_mov_b32_dpp v138, v128 row_shl:10 row_mask:0xf bank_mask:0xf bound_ctrl:1
    v_mov_b32_dpp v139, v129 row_shl:10 row_mask:0xf bank_mask:0xf bound_ctrl:1
    v_mov_b32_dpp v140, v128 row_shl:12 row_mask:0xf bank_mask:0xf bound_ctrl:1
    v_mov_b32_dpp v141, v129 row_shl:12 row_mask:0xf bank_mask:0xf bound_ctrl:1
    v_mov_b32_dpp v142, v128 row_shl:14 row_mask:0xf bank_mask:0xf bound_ctrl:1
    v_mov_b32_dpp v143, v129 row_shl:14 row_mask:0xf bank_mask:0xf bound_ctrl:1
    s_lshl_b32 s39, s24, 11
    s_lshl_b32 s59, s25, 9
    s_add_u32 s39, s39, s59
    s_add_u32 s39, s39, 4096
    v_lshlrev_b32 v4, 3, v1
    v_mov_b32 v37, s43
L_spin10:
    ds_read_b32 v5, v8 offset:224
    s_waitcnt lgkmcnt(0)
    v_cmp_eq_u32 vcc, 0, v5
    s_cbranch_vccz L_spin10_ok
    s_sleep 2
    s_branch L_spin10
L_spin10_ok:
    ds_read_b64_tr_b16 v[64:65], v180 offset:0
    ds_read_b64_tr_b16 v[66:67], v180 offset:2048
    ds_read_b64_tr_b16 v[68:69], v181 offset:0
    ds_read_b64_tr_b16 v[70:71], v181 offset:2048
    ds_read_b64_tr_b16 v[72:73], v182 offset:0
    ds_read_b64_tr_b16 v[74:75], v182 offset:2048
    ds_read_b64_tr_b16 v[76:77], v183 offset:0
    ds_read_b64_tr_b16 v[78:79], v183 offset:2048
    ds_read_b64_tr_b16 v[80:81], v180 offset:4096
    ds_read_b64_tr_b16 v[82:83], v180 offset:6144
    ds_read_b64_tr_b16 v[84:85], v181 offset:4096
    ds_read_b64_tr_b16 v[86:87], v181 offset:6144
    ds_read_b64_tr_b16 v[88:89], v182 offset:4096
    ds_read_b64_tr_b16 v[90:91], v182 offset:6144
    ds_read_b64_tr_b16 v[92:93], v183 offset:4096
    ds_read_b64_tr_b16 v[94:95], v183 offset:6144
    ds_read_b64_tr_b16 v[96:97], v180 offset:8192
    ds_read_b64_tr_b16 v[98:99], v180 offset:10240
    ds_read_b64_tr_b16 v[100:101], v181 offset:8192
    ds_read_b64_tr_b16 v[102:103], v181 offset:10240
    ds_read_b64_tr_b16 v[104:105], v182 offset:8192
    ds_read_b64_tr_b16 v[106:107], v182 offset:10240
    ds_read_b64_tr_b16 v[108:109], v183 offset:8192
    ds_read_b64_tr_b16 v[110:111], v183 offset:10240
    ds_read_b64_tr_b16 v[112:113], v180 offset:12288
    ds_read_b64_tr_b16 v[114:115], v180 offset:14336
    ds_read_b64_tr_b16 v[116:117], v181 offset:12288
    ds_read_b64_tr_b16 v[118:119], v181 offset:14336
    ds_read_b64_tr_b16 v[120:121], v182 offset:12288
    ds_read_b64_tr_b16 v[122:123], v182 offset:14336
    ds_read_b64_tr_b16 v[124:125], v183 offset:12288
    ds_read_b64_tr_b16 v[126:127], v183 offset:14336
    ds_write_b32 v8, v12 offset:228
    s_waitcnt lgkmcnt(15)
    v_mfma_f32_16x16x32_bf16 v[144:147], v[128:131], v[64:67], 0
    v_mfma_f32_16x16x32_bf16 v[148:151], v[128:131], v[68:71], 0
    v_mfma_f32_16x16x32_bf16 v[152:155], v[128:131], v[72:75], 0
    v_mfma_f32_16x16x32_bf16 v[156:159], v[128:131], v[76:79], 0
    s_waitcnt lgkmcnt(15)
    v_mfma_f32_16x16x32_bf16 v[144:147], v[132:135], v[80:83], v[144:147]
    v_mfma_f32_16x16x32_bf16 v[148:151], v[132:135], v[84:87], v[148:151]
    v_mfma_f32_16x16x32_bf16 v[152:155], v[132:135], v[88:91], v[152:155]
    v_mfma_f32_16x16x32_bf16 v[156:159], v[132:135], v[92:95], v[156:159]
    s_waitcnt lgkmcnt(9)
    v_mfma_f32_16x16x32_bf16 v[144:147], v[136:139], v[96:99], v[144:147]
    v_mfma_f32_16x16x32_bf16 v[148:151], v[136:139], v[100:103], v[148:151]
    v_mfma_f32_16x16x32_bf16 v[152:155], v[136:139], v[104:107], v[152:155]
    v_mfma_f32_16x16x32_bf16 v[156:159], v[136:139], v[108:111], v[156:159]
    s_waitcnt lgkmcnt(1)
    v_mfma_f32_16x16x32_bf16 v[144:147], v[140:143], v[112:115], v[144:147]
    v_mfma_f32_16x16x32_bf16 v[148:151], v[140:143], v[116:119], v[148:151]
    v_mfma_f32_16x16x32_bf16 v[152:155], v[140:143], v[120:123], v[152:155]
    v_mfma_f32_16x16x32_bf16 v[156:159], v[140:143], v[124:127], v[156:159]
    s_nop 4
    v_cvt_pk_bf16_f32 v36, v144, v145
    v_cvt_pk_bf16_f32 v38, v148, v149
    v_cvt_pk_bf16_f32 v40, v152, v153
    v_cvt_pk_bf16_f32 v42, v156, v157
    v_permlane16_swap_b32 v36, v38
    s_nop 0
    v_permlane16_swap_b32 v40, v42
    s_nop 1
    v_permlane32_swap_b32 v36, v40
    buffer_store_dwordx2 v[36:37], v4, s[16:19], s39 offen sc1
    s_branch L_c_roledone
L_c_nt1:
    s_sub_u32 s39, s37, 16
    s_mul_i32 s55, s36, 7
    s_add_u32 s55, s55, s39
    v_lshrrev_b32 v4, 2, v3
    v_lshlrev_b32 v4, 9, v4
    v_lshl_or_b32 v4, v2, 6, v4
    v_lshl_or_b32 v184, v9, 4, v4
    v_and_b32 v4, 31, v1
    v_lshlrev_b32 v185, 3, v4
    s_mul_i32 s8, s36, 8448
    s_add_u32 s8, s8, 1204224
    s_mul_i32 s7, s36, 8448
    s_lshl_b32 s59, s47, 11
    s_add_u32 s7, s7, s59
    s_add_u32 s7, s7, 1196032
    v_and_b32 v4, 7, v3
    v_mul_u32_u24 v186, 272, v4
    v_lshl_add_u32 v186, v2, 4, v186
    s_lshl_b32 s40, s47, 6
    s_add_u32 s40, s40, 136704
    v_add_u32 v186, s40, v186
    v_lshrrev_b32 v4, 3, v3
    v_and_b32 v5, 1, v3
    v_mul_u32_u24 v4, 2240, v4
    v_mul_u32_u24 v187, 544, v5
    v_add_u32 v187, v187, v4
    v_lshl_add_u32 v187, v2, 4, v187
    v_bfe_u32 v4, v3, 1, 2
    v_lshl_add_u32 v187, v4, 2, v187
    v_add_u32 v187, 136704, v187
    v_add_u32 v202, 1088, v187
    v_lshlrev_b32 v188, 6, v2
    v_lshl_or_b32 v188, v5, 2, v188
    v_lshrrev_b32 v4, 2, v1
    v_lshlrev_b32 v4, 6, v4
    v_and_b32 v6, 1, v2
    v_lshl_or_b32 v4, v6, 5, v4
    v_lshl_or_b32 v4, v10, 3, v4
    s_lshl_b32 s40, s47, 13
    v_add_u32 v190, s40, v4
    v_xor_b32 v191, 32, v190
    s_add_u32 s40, s40, 32768
    v_add_u32 v192, s40, v22
    v_xor_b32 v193, 32, v192
    v_xor_b32 v194, 64, v192
    v_xor_b32 v195, 96, v192
    v_xor_b32 v196, 128, v192
    v_xor_b32 v197, 160, v192
    v_xor_b32 v198, 192, v192
    v_xor_b32 v199, 224, v192
    v_lshrrev_b32 v4, 2, v3
    v_lshl_or_b32 v4, v4, 1, v5
    v_mul_u32_u24 v189, 7168, v4
    v_bfe_u32 v4, v3, 1, 1
    v_lshl_add_u32 v189, v4, 6, v189
    v_lshl_add_u32 v189, v2, 4, v189
    s_mul_i32 s10, s47, 57344
    s_lshl_b32 s59, s55, 7
    s_add_u32 s10, s10, s59
    s_add_u32 s10, s10, 1507328
    s_lshl_b32 s11, s36, 7
    s_lshl_b32 s59, s39, 4
    s_add_u32 s11, s11, s59
    s_lshl_b32 s59, s47, 2
    s_add_u32 s11, s11, s59
    s_add_u32 s11, s11, 1359872
    s_mov_b32 s52, 0xcccccccc
    s_mov_b32 s53, 0xcccccccc
L_c_roledone:

    s_lshl_b32 s39, s36, 14
    s_lshl_b32 s59, s45, 13
    s_add_u32 s39, s39, s59
    s_lshl_b32 s59, s47, 9
    s_add_u32 s39, s39, s59
    s_add_u32 s39, s39, 131072
    s_add_u32 s40, s39, 4096
    s_cmp_lg_u32 s47, 0
    s_cbranch_scc1 L_c_nt
    s_sleep 60
    ds_write_b32 v8, v12 offset:36
    s_sleep 64
    ds_write_b32 v8, v12 offset:44
L_c_nt:
L_spin11:
    ds_read_b32 v4, v8 offset:44
    s_waitcnt lgkmcnt(0)
    v_cmp_eq_u32 vcc, 0, v4
    s_cbranch_vccz L_spin11_ok
    s_sleep 2
    s_branch L_spin11
L_spin11_ok:
L_spin12:
    ds_read_b32 v4, v8 offset:12
    s_waitcnt lgkmcnt(0)
    v_cmp_eq_u32 vcc, 0, v4
    s_cbranch_vccz L_spin12_ok
    s_sleep 1
    s_branch L_spin12
L_spin12_ok:
    ds_read_b32 v4, v8 offset:3328
    buffer_load_dwordx4 v[208:211], v31, s[16:19], s39 offen sc1
    buffer_load_dwordx4 v[212:215], v31, s[16:19], s40 offen sc1
    s_waitcnt lgkmcnt(0)
    v_readfirstlane_b32 s43, v4
    v_mov_b32 v7, 1
    s_add_u32 s92, s92, s43
L_spin13:
    ds_read_b32 v5, v8 offset:8
    s_waitcnt lgkmcnt(0)
    v_cmp_eq_u32 vcc, 0, v5
    s_cbranch_vccz L_spin13_ok
    s_sleep 1
    s_branch L_spin13
L_spin13_ok:
    ds_read_b128 v[64:67], v14 offset:0
    ds_read_b128 v[68:71], v15 offset:0
    ds_read_b128 v[72:75], v16 offset:0
    ds_read_b128 v[76:79], v17 offset:0
    ds_read_b128 v[80:83], v14 offset:4096
    ds_read_b128 v[84:87], v15 offset:4096
    ds_read_b128 v[88:91], v16 offset:4096
    ds_read_b128 v[92:95], v17 offset:4096
    ds_read_b128 v[96:99], v14 offset:8192
    ds_read_b128 v[100:103], v15 offset:8192
    ds_read_b128 v[104:107], v16 offset:8192
    ds_read_b128 v[108:111], v17 offset:8192
    ds_read_b128 v[112:115], v14 offset:12288
    ds_read_b128 v[116:119], v15 offset:12288
    ds_read_b128 v[120:123], v16 offset:12288
    ds_read_b128 v[124:127], v17 offset:12288
    ds_write_b32 v11, v12 offset:16
    s_waitcnt vmcnt(0)
    v_xor_b32 v4, s92, v209
    v_bitop3_b32 v4, v211, s92, v4 bitop3:0xbe
    v_bitop3_b32 v4, v213, s92, v4 bitop3:0xbe
    v_bitop3_b32 v4, v215, s92, v4 bitop3:0xbe
    v_cmp_ne_u32 vcc, 0, v4
    s_cbranch_vccnz L_c_qre
L_c_qok:
    v_dot2_f32_bf16 v36, v208, s95, 0
    v_dot2_f32_bf16 v37, v208, s93, 0
    v_dot2_f32_bf16 v38, v210, s95, 0
    v_dot2_f32_bf16 v39, v210, s93, 0
    v_dot2_f32_bf16 v36, v212, s95, v36
    v_dot2_f32_bf16 v37, v212, s93, v37
    v_dot2_f32_bf16 v38, v214, s95, v38
    v_dot2_f32_bf16 v39, v214, s93, v39
    s_nop 1
    v_permlane32_swap_b32 v36, v38
    v_permlane32_swap_b32 v37, v39
    v_pk_add_f32 v[36:37], v[36:37], v[38:39]
    v_cvt_pk_bf16_f32 v4, v36, v37
    ds_write_b32 v30, v4
    ds_write_b32 v11, v7 offset:48
L_spin14:
    ds_read_b128 v[36:39], v8 offset:48
    s_waitcnt lgkmcnt(0)
    v_min3_u32 v40, v36, v37, v38
    v_min_u32 v40, v40, v39
    v_cmp_eq_u32 vcc, 0, v40
    s_cbranch_vccnz L_spin14
    ds_read_b128 v[128:131], v18 offset:0
    ds_read_b128 v[132:135], v18 offset:64
    ds_read_b128 v[136:139], v18 offset:128
    ds_read_b128 v[140:143], v18 offset:192
    ds_write_b32 v11, v12 offset:208
    v_max3_u32 v36, v36, v37, v38
    v_max_u32 v36, v36, v39
    s_nop 0
    v_readfirstlane_b32 s94, v36
    s_waitcnt lgkmcnt(4)
    v_mfma_f32_16x16x32_bf16 v[44:47], v[64:67], v[128:131], 0
    v_mfma_f32_16x16x32_bf16 v[48:51], v[80:83], v[128:131], 0
    v_mfma_f32_16x16x32_bf16 v[52:55], v[96:99], v[128:131], 0
    v_mfma_f32_16x16x32_bf16 v[56:59], v[112:115], v[128:131], 0
    s_waitcnt lgkmcnt(3)
    v_mfma_f32_16x16x32_bf16 v[44:47], v[68:71], v[132:135], v[44:47]
    v_mfma_f32_16x16x32_bf16 v[48:51], v[84:87], v[132:135], v[48:51]
    v_mfma_f32_16x16x32_bf16 v[52:55], v[100:103], v[132:135], v[52:55]
    v_mfma_f32_16x16x32_bf16 v[56:59], v[116:119], v[132:135], v[56:59]
    s_waitcnt lgkmcnt(2)
    v_mfma_f32_16x16x32_bf16 v[44:47], v[72:75], v[136:139], v[44:47]
    v_mfma_f32_16x16x32_bf16 v[48:51], v[88:91], v[136:139], v[48:51]
    v_mfma_f32_16x16x32_bf16 v[52:55], v[104:107], v[136:139], v[52:55]
    v_mfma_f32_16x16x32_bf16 v[56:59], v[120:123], v[136:139], v[56:59]
    s_waitcnt lgkmcnt(1)
    v_mfma_f32_16x16x32_bf16 v[44:47], v[76:79], v[140:143], v[44:47]
    v_mfma_f32_16x16x32_bf16 v[48:51], v[92:95], v[140:143], v[48:51]
    v_mfma_f32_16x16x32_bf16 v[52:55], v[108:111], v[140:143], v[52:55]
    v_mfma_f32_16x16x32_bf16 v[56:59], v[124:127], v[140:143], v[56:59]

    s_nop 5
    v_mov_b32_dpp v44, v48 quad_perm:[0,1,2,3] row_mask:0xf bank_mask:0x2
    v_mov_b32_dpp v45, v49 quad_perm:[0,1,2,3] row_mask:0xf bank_mask:0x2
    v_mov_b32_dpp v46, v50 quad_perm:[0,1,2,3] row_mask:0xf bank_mask:0x2
    v_mov_b32_dpp v47, v51 quad_perm:[0,1,2,3] row_mask:0xf bank_mask:0x2
    v_mov_b32_dpp v44, v52 quad_perm:[0,1,2,3] row_mask:0xf bank_mask:0x4
    v_mov_b32_dpp v45, v53 quad_perm:[0,1,2,3] row_mask:0xf bank_mask:0x4
    v_mov_b32_dpp v46, v54 quad_perm:[0,1,2,3] row_mask:0xf bank_mask:0x4
    v_mov_b32_dpp v47, v55 quad_perm:[0,1,2,3] row_mask:0xf bank_mask:0x4
    v_mov_b32_dpp v44, v56 quad_perm:[0,1,2,3] row_mask:0xf bank_mask:0x8
    v_mov_b32_dpp v45, v57 quad_perm:[0,1,2,3] row_mask:0xf bank_mask:0x8
    v_mov_b32_dpp v46, v58 quad_perm:[0,1,2,3] row_mask:0xf bank_mask:0x8
    v_mov_b32_dpp v47, v59 quad_perm:[0,1,2,3] row_mask:0xf bank_mask:0x8
    v_max3_f32 v32, v44, v45, v46
    v_max_f32 v32, v32, v47
    s_nop 1
    v_max_f32_dpp v32, v32, v32 row_ror:4 row_mask:0xf bank_mask:0xf bound_ctrl:1
    s_nop 1
    v_max_f32_dpp v32, v32, v32 row_ror:8 row_mask:0xf bank_mask:0xf bound_ctrl:1
    v_mov_b32 v4, v32
    s_nop 1
    v_permlane16_swap_b32 v4, v32
    v_max_f32 v32, v32, v4
    v_mov_b32 v4, v32
    s_nop 1
    v_permlane32_swap_b32 v4, v32
    v_max_f32 v32, v32, v4
    v_mul_f32 v60, s6, v32
    v_fma_f32 v44, v44, s6, -v60
    v_fma_f32 v45, v45, s6, -v60
    v_fma_f32 v46, v46, s6, -v60
    v_fma_f32 v47, v47, s6, -v60
    v_exp_f32 v44, v44
    v_exp_f32 v45, v45
    v_exp_f32 v46, v46
    v_exp_f32 v47, v47
    v_add_f32 v4, v44, v45
    v_add_f32 v5, v46, v47
    v_add_f32 v61, v4, v5
    s_nop 1
    v_add_f32_dpp v61, v61, v61 row_ror:4 row_mask:0xf bank_mask:0xf bound_ctrl:1
    s_nop 1
    v_add_f32_dpp v61, v61, v61 row_ror:8 row_mask:0xf bank_mask:0xf bound_ctrl:1
    v_mov_b32 v4, v61
    s_nop 1
    v_permlane16_swap_b32 v4, v61
    v_add_f32 v61, v61, v4
    v_mov_b32 v4, v61
    s_nop 1
    v_permlane32_swap_b32 v4, v61
    v_add_f32 v61, v61, v4
    s_mov_b64 exec, 0xf
    ds_write_b64 v23, v[60:61]
    s_mov_b64 exec, -1
    s_mov_b32 s44, 0
L_c_ml:
    ds_read_b128 v[36:39], v24
    ds_read_b128 v[40:43], v24 offset:16
    s_add_u32 s44, s44, 1
    s_cmp_gt_u32 s44, 100000
    s_waitcnt lgkmcnt(0)
    s_cbranch_scc1 L_c_mlok
    v_max3_u32 v4, v37, v39, v41
    v_max_u32 v4, v4, v43
    v_cmp_eq_u32 vcc, -1, v4
    s_cbranch_vccnz L_c_ml
L_c_mlok:
    v_max3_f32 v34, v36, v38, v40
    v_max_f32 v34, v34, v42
    v_sub_f32 v36, v36, v34
    v_sub_f32 v38, v38, v34
    v_sub_f32 v40, v40, v34
    v_sub_f32 v42, v42, v34
    v_sub_f32 v4, v60, v34
    v_exp_f32 v36, v36
    v_exp_f32 v38, v38
    v_exp_f32 v40, v40
    v_exp_f32 v42, v42
    v_exp_f32 v4, v4
    v_mul_f32 v33, v36, v37
    v_fmac_f32 v33, v38, v39
    v_fmac_f32 v33, v40, v41
    v_fmac_f32 v33, v42, v43
    v_rcp_f32 v5, v33
    v_mov_b32 v60, v34
    v_mov_b32 v61, v33
    v_mul_f32 v4, v4, v5
    v_mul_f32 v44, v44, v4
    v_mul_f32 v45, v45, v4
    v_mul_f32 v46, v46, v4
    v_mul_f32 v47, v47, v4
    v_cvt_pk_bf16_f32 v36, v44, v45
    v_cvt_pk_bf16_f32 v37, v46, v47
    ds_write_b64 v25, v[36:37]
    ds_write_b32 v11, v12 offset:192
    s_cmp_gt_u32 s94, 1
    s_mov_b64 exec, s[50:51]
    s_cbranch_scc1 L_c_strem
    s_cbranch_execz L_c_stdone
    buffer_store_dwordx2 v[60:61], v28, s[16:19], s5 offen
L_c_stdone:
    s_mov_b64 exec, -1

L_spin15:
    ds_read_b128 v[36:39], v8 offset:192
    s_waitcnt lgkmcnt(0)
    v_min3_u32 v40, v36, v37, v38
    v_min_u32 v40, v40, v39
    v_cmp_eq_u32 vcc, 0, v40
    s_cbranch_vccnz L_spin15
    ds_read_b128 v[64:67], v26 offset:0
    ds_read_b128 v[68:71], v26 offset:256
    ds_read_b128 v[72:75], v26 offset:512
    ds_read_b128 v[76:79], v26 offset:768
    ds_read_b128 v[80:83], v26 offset:1024
    ds_read_b128 v[84:87], v26 offset:1280
    ds_read_b128 v[88:91], v26 offset:1536
    ds_read_b128 v[92:95], v26 offset:1792
L_spin16:
    ds_read_b32 v4, v8 offset:40
    s_waitcnt lgkmcnt(0)
    v_cmp_eq_u32 vcc, 0, v4
    s_cbranch_vccnz L_spin16
    ds_read_b64_tr_b16 v[96:97], v20 offset:0
    ds_read_b64_tr_b16 v[98:99], v20 offset:4096
    ds_read_b64_tr_b16 v[100:101], v21 offset:0
    ds_read_b64_tr_b16 v[102:103], v21 offset:4096
    ds_read_b64_tr_b16 v[104:105], v20 offset:8192
    ds_read_b64_tr_b16 v[106:107], v20 offset:12288
    ds_read_b64_tr_b16 v[108:109], v21 offset:8192
    ds_read_b64_tr_b16 v[110:111], v21 offset:12288
    ds_read_b64_tr_b16 v[112:113], v20 offset:16384
    ds_read_b64_tr_b16 v[114:115], v20 offset:20480
    ds_read_b64_tr_b16 v[116:117], v21 offset:16384
    ds_read_b64_tr_b16 v[118:119], v21 offset:20480
    ds_read_b64_tr_b16 v[120:121], v20 offset:24576
    ds_read_b64_tr_b16 v[122:123], v20 offset:28672
    ds_read_b64_tr_b16 v[124:125], v21 offset:24576
    ds_read_b64_tr_b16 v[126:127], v21 offset:28672
    ds_read_b64_tr_b16 v[128:129], v20 offset:32768
    ds_read_b64_tr_b16 v[130:131], v20 offset:36864
    ds_read_b64_tr_b16 v[132:133], v21 offset:32768
    ds_read_b64_tr_b16 v[134:135], v21 offset:36864
    ds_read_b64_tr_b16 v[136:137], v20 offset:40960
    ds_read_b64_tr_b16 v[138:139], v20 offset:45056
    ds_read_b64_tr_b16 v[140:141], v21 offset:40960
    ds_read_b64_tr_b16 v[142:143], v21 offset:45056
    ds_read_b64_tr_b16 v[144:145], v20 offset:49152
    ds_read_b64_tr_b16 v[146:147], v20 offset:53248
    ds_read_b64_tr_b16 v[148:149], v21 offset:49152
    ds_read_b64_tr_b16 v[150:151], v21 offset:53248
    s_waitcnt lgkmcnt(15)
    v_mfma_f32_16x16x32_bf16 v[176:179], v[96:99], v[64:67], 0
    v_mfma_f32_16x16x32_bf16 v[180:183], v[100:103], v[64:67], 0
    s_waitcnt lgkmcnt(15)
    v_mfma_f32_16x16x32_bf16 v[176:179], v[104:107], v[68:71], v[176:179]
    v_mfma_f32_16x16x32_bf16 v[180:183], v[108:111], v[68:71], v[180:183]
    s_waitcnt lgkmcnt(15)
    v_mfma_f32_16x16x32_bf16 v[176:179], v[112:115], v[72:75], v[176:179]
    v_mfma_f32_16x16x32_bf16 v[180:183], v[116:119], v[72:75], v[180:183]
    s_waitcnt lgkmcnt(12)
    v_mfma_f32_16x16x32_bf16 v[176:179], v[120:123], v[76:79], v[176:179]
    v_mfma_f32_16x16x32_bf16 v[180:183], v[124:127], v[76:79], v[180:183]
    s_waitcnt lgkmcnt(8)
    v_mfma_f32_16x16x32_bf16 v[176:179], v[128:131], v[80:83], v[176:179]
    v_mfma_f32_16x16x32_bf16 v[180:183], v[132:135], v[80:83], v[180:183]
    s_waitcnt lgkmcnt(4)
    v_mfma_f32_16x16x32_bf16 v[176:179], v[136:139], v[84:87], v[176:179]
    v_mfma_f32_16x16x32_bf16 v[180:183], v[140:143], v[84:87], v[180:183]
    s_waitcnt lgkmcnt(0)
    v_mfma_f32_16x16x32_bf16 v[176:179], v[144:147], v[88:91], v[176:179]
    v_mfma_f32_16x16x32_bf16 v[180:183], v[148:151], v[88:91], v[180:183]
    s_cmp_gt_u32 s94, 1
    s_barrier
    ds_read_b64_tr_b16 v[96:97], v20 offset:57344
    ds_read_b64_tr_b16 v[98:99], v20 offset:61440
    ds_read_b64_tr_b16 v[100:101], v21 offset:57344
    ds_read_b64_tr_b16 v[102:103], v21 offset:61440
    s_waitcnt lgkmcnt(2)
    v_mfma_f32_16x16x32_bf16 v[176:179], v[96:99], v[92:95], v[176:179]
    s_waitcnt lgkmcnt(0)
    v_mfma_f32_16x16x32_bf16 v[180:183], v[100:103], v[92:95], v[180:183]
    s_mov_b64 exec, s[48:49]
    s_nop 4
    v_cvt_pk_bf16_f32 v36, v176, v177
    v_cvt_pk_bf16_f32 v37, v178, v179
    v_cvt_pk_bf16_f32 v38, v180, v181
    v_cvt_pk_bf16_f32 v39, v182, v183
    s_cbranch_scc1 L_c_orem
    buffer_store_dwordx4 v[36:39], v27, s[16:19], s4 offen
    s_mov_b64 exec, -1
    s_cmp_lt_u32 s37, 16
    s_cbranch_scc0 L_c_other
    s_barrier

L_t1_w:
    ds_read_b32 v188, v194
    ds_read_b32 v189, v194 offset:512
    ds_read_b32 v190, v194 offset:768
    v_mov_b32 v205, s43
    v_and_b32 v4, 8, v1
    v_cmp_ne_u32 s[48:49], 0, v4
    v_and_b32 v4, 16, v1
    v_cmp_ne_u32 s[50:51], 0, v4
    s_cmp_gt_u32 s94, 1
    s_barrier
    s_cbranch_scc1 L_t1rem
    buffer_load_dwordx2 v[208:209], v184, s[16:19], s8 offen sc1
    buffer_load_dwordx4 v[216:219], v29, s[16:19], s7 offen offset:0 sc1
    buffer_load_dwordx4 v[220:223], v29, s[16:19], s7 offen offset:1024 sc1
    buffer_load_dwordx4 v[224:227], v29, s[16:19], s7 offen offset:2048 sc1
    buffer_load_dwordx4 v[228:231], v29, s[16:19], s7 offen offset:3072 sc1
    ds_read_b64_tr_b16 v[64:65], v196 offset:0
    ds_read_b64_tr_b16 v[66:67], v196 offset:4096
    ds_read_b64_tr_b16 v[68:69], v197 offset:0
    ds_read_b64_tr_b16 v[70:71], v197 offset:4096
    ds_read_b64_tr_b16 v[72:73], v198 offset:0
    ds_read_b64_tr_b16 v[74:75], v198 offset:4096
    ds_read_b64_tr_b16 v[76:77], v199 offset:0
    ds_read_b64_tr_b16 v[78:79], v199 offset:4096
    ds_read_b64_tr_b16 v[80:81], v196 offset:8192
    ds_read_b64_tr_b16 v[82:83], v196 offset:12288
    ds_read_b64_tr_b16 v[84:85], v197 offset:8192
    ds_read_b64_tr_b16 v[86:87], v197 offset:12288
    ds_read_b64_tr_b16 v[88:89], v198 offset:8192
    ds_read_b64_tr_b16 v[90:91], v198 offset:12288
    ds_read_b64_tr_b16 v[92:93], v199 offset:8192
    ds_read_b64_tr_b16 v[94:95], v199 offset:12288
    ds_read_b64_tr_b16 v[96:97], v196 offset:16384
    ds_read_b64_tr_b16 v[98:99], v196 offset:20480
    ds_read_b64_tr_b16 v[100:101], v197 offset:16384
    ds_read_b64_tr_b16 v[102:103], v197 offset:20480
    ds_read_b64_tr_b16 v[104:105], v198 offset:16384
    ds_read_b64_tr_b16 v[106:107], v198 offset:20480
    ds_read_b64_tr_b16 v[108:109], v199 offset:16384
    ds_read_b64_tr_b16 v[110:111], v199 offset:20480
    ds_read_b64_tr_b16 v[112:113], v196 offset:24576
    ds_read_b64_tr_b16 v[114:115], v196 offset:28672
    ds_read_b64_tr_b16 v[116:117], v197 offset:24576
    ds_read_b64_tr_b16 v[118:119], v197 offset:28672
    ds_read_b64_tr_b16 v[120:121], v198 offset:24576
    ds_read_b64_tr_b16 v[122:123], v198 offset:28672
    ds_read_b64_tr_b16 v[124:125], v199 offset:24576
    ds_read_b64_tr_b16 v[126:127], v199 offset:28672
    s_mov_b32 s44, 0
    s_branch L_t1p_m
L_t1p_re:
    s_add_u32 s44, s44, 1
    s_cmp_gt_u32 s44, 100000
    s_cbranch_scc1 L_t1p_ok
    s_sleep 1
    buffer_load_dwordx2 v[208:209], v184, s[16:19], s8 offen sc1
    buffer_load_dwordx4 v[216:219], v29, s[16:19], s7 offen offset:0 sc1
    buffer_load_dwordx4 v[220:223], v29, s[16:19], s7 offen offset:1024 sc1
    buffer_load_dwordx4 v[224:227], v29, s[16:19], s7 offen offset:2048 sc1
    buffer_load_dwordx4 v[228:231], v29, s[16:19], s7 offen offset:3072 sc1
L_t1p_m:
    s_waitcnt vmcnt(3) lgkmcnt(0)
    v_mfma_f32_16x16x32_bf16 v[44:47], v[216:219], v[64:67], 0
    v_mfma_f32_16x16x32_bf16 v[52:55], v[216:219], v[72:75], 0
    s_waitcnt vmcnt(0)
    v_max3_u32 v4, v219, v223, v227
    v_max3_u32 v4, v4, v231, v209
    v_cmp_eq_u32 vcc, -1, v4
    v_mfma_f32_16x16x32_bf16 v[48:51], v[216:219], v[68:71], 0
    v_mfma_f32_16x16x32_bf16 v[56:59], v[216:219], v[76:79], 0
    s_cbranch_vccnz L_t1p_re
L_t1p_ok:
    v_max_f32_dpp v32, v208, v208 quad_perm:[1,0,3,2] row_mask:0xf bank_mask:0xf bound_ctrl:1
    v_mfma_f32_16x16x32_bf16 v[44:47], v[220:223], v[80:83], v[44:47]
    s_nop 0
    v_max_f32_dpp v32, v32, v32 quad_perm:[2,3,0,1] row_mask:0xf bank_mask:0xf bound_ctrl:1
    v_mov_b32 v5, v32
    v_mfma_f32_16x16x32_bf16 v[52:55], v[220:223], v[88:91], v[52:55]
    s_nop 0
    v_permlane16_swap_b32 v5, v32
    v_max_f32 v32, v32, v5
    v_mov_b32 v5, v32
    v_mfma_f32_16x16x32_bf16 v[48:51], v[220:223], v[84:87], v[48:51]
    v_mfma_f32_16x16x32_bf16 v[56:59], v[220:223], v[92:95], v[56:59]
    v_permlane32_swap_b32 v5, v32
    v_max_f32 v32, v32, v5
    v_sub_f32 v32, v208, v32
    v_mfma_f32_16x16x32_bf16 v[44:47], v[224:227], v[96:99], v[44:47]
    v_exp_f32 v32, v32
    v_mfma_f32_16x16x32_bf16 v[52:55], v[224:227], v[104:107], v[52:55]
    v_mul_f32 v32, v32, v209
    v_mfma_f32_16x16x32_bf16 v[48:51], v[224:227], v[100:103], v[48:51]
    s_nop 0
    v_add_f32_dpp v33, v32, v32 quad_perm:[1,0,3,2] row_mask:0xf bank_mask:0xf bound_ctrl:1
    v_mov_b32_dpp v200, v32 quad_perm:[0,0,0,0] row_mask:0xf bank_mask:0xf bound_ctrl:1
    v_mov_b32_dpp v201, v32 quad_perm:[1,1,1,1] row_mask:0xf bank_mask:0xf bound_ctrl:1
    v_mfma_f32_16x16x32_bf16 v[56:59], v[224:227], v[108:111], v[56:59]
    v_add_f32_dpp v33, v33, v33 quad_perm:[2,3,0,1] row_mask:0xf bank_mask:0xf bound_ctrl:1
    v_mov_b32 v5, v33
    v_mov_b32_dpp v202, v32 quad_perm:[2,2,2,2] row_mask:0xf bank_mask:0xf bound_ctrl:1
    v_mfma_f32_16x16x32_bf16 v[44:47], v[228:231], v[112:115], v[44:47]
    v_mov_b32_dpp v203, v32 quad_perm:[3,3,3,3] row_mask:0xf bank_mask:0xf bound_ctrl:1
    v_permlane16_swap_b32 v5, v33
    v_add_f32 v33, v33, v5
    v_mfma_f32_16x16x32_bf16 v[52:55], v[228:231], v[120:123], v[52:55]
    v_mov_b32 v5, v33
    v_mfma_f32_16x16x32_bf16 v[48:51], v[228:231], v[116:119], v[48:51]
    s_nop 0
    v_permlane32_swap_b32 v5, v33
    v_add_f32 v33, v33, v5
    v_rcp_f32 v33, v33
    v_mfma_f32_16x16x32_bf16 v[56:59], v[228:231], v[124:127], v[56:59]
    s_cmp_lt_u32 s47, 2
    v_pk_mul_f32 v[44:45], v[44:45], v[200:201]
    v_pk_fma_f32 v[44:45], v[46:47], v[202:203], v[44:45]
    v_add_f32 v36, v44, v45
    v_pk_mul_f32 v[52:53], v[52:53], v[200:201]
    v_pk_fma_f32 v[52:53], v[54:55], v[202:203], v[52:53]
    v_add_f32 v38, v52, v53
    v_pk_mul_f32 v[48:49], v[48:49], v[200:201]
    v_pk_fma_f32 v[48:49], v[50:51], v[202:203], v[48:49]
    v_add_f32 v37, v48, v49
    v_pk_mul_f32 v[56:57], v[56:57], v[200:201]
    v_pk_fma_f32 v[56:57], v[58:59], v[202:203], v[56:57]
    v_add_f32 v39, v56, v57
    v_permlane32_swap_b32 v36, v38
    s_nop 0
    v_permlane32_swap_b32 v37, v39
    v_pk_add_f32 v[36:37], v[36:37], v[38:39]
    s_nop 1
    v_permlane16_swap_b32 v36, v37
    v_add_f32 v36, v36, v37
    v_mul_f32 v36, v36, v33
    s_nop 1
    v_mov_b32_dpp v37, v36 quad_perm:[1,0,3,2] row_mask:0xf bank_mask:0xf bound_ctrl:1
    s_mov_b32 exec_lo, 0x55555555
    s_mov_b32 exec_hi, 0x55555555
    v_cvt_pk_bf16_f32 v204, v36, v37
    s_barrier
    buffer_store_dwordx2 v[204:205], v187, s[16:19], s9 offen sc1
    s_mov_b64 exec, -1
    s_cbranch_scc0 L_fin_end

    buffer_load_ushort v185, v195, s[28:31], s14 offen
    s_waitcnt vmcnt(0)
    buffer_load_dwordx4 v[216:219], v29, s[16:19], s10 offen offset:0 sc1
    buffer_load_dwordx4 v[220:223], v29, s[16:19], s10 offen offset:1024 sc1
    buffer_load_dwordx4 v[224:227], v29, s[16:19], s10 offen offset:2048 sc1
    buffer_load_dwordx4 v[228:231], v29, s[16:19], s10 offen offset:3072 sc1
    v_lshlrev_b32 v185, 16, v185
    s_mov_b32 s44, 0
    s_branch L_rdp_m
L_rdp_re:
    s_add_u32 s44, s44, 1
    s_cmp_gt_u32 s44, 100000
    s_cbranch_scc1 L_rdp_ok
    buffer_load_dwordx4 v[216:219], v29, s[16:19], s10 offen offset:0 sc1
    buffer_load_dwordx4 v[220:223], v29, s[16:19], s10 offen offset:1024 sc1
    buffer_load_dwordx4 v[224:227], v29, s[16:19], s10 offen offset:2048 sc1
    buffer_load_dwordx4 v[228:231], v29, s[16:19], s10 offen offset:3072 sc1
L_rdp_m:
    s_waitcnt vmcnt(3)
    v_xor_b32 v4, s43, v219
    v_bitop3_b32 v4, v217, s43, v4 bitop3:0xbe
    v_dot2_f32_bf16 v36, v216, s95, 0
    v_dot2_f32_bf16 v38, v218, s95, 0
    v_dot2_f32_bf16 v37, v216, s93, 0
    v_dot2_f32_bf16 v39, v218, s93, 0
    s_waitcnt vmcnt(2)
    v_bitop3_b32 v4, v223, s43, v4 bitop3:0xbe
    v_bitop3_b32 v4, v221, s43, v4 bitop3:0xbe
    v_dot2_f32_bf16 v36, v220, s95, v36
    v_dot2_f32_bf16 v38, v222, s95, v38
    v_dot2_f32_bf16 v37, v220, s93, v37
    v_dot2_f32_bf16 v39, v222, s93, v39
    s_waitcnt vmcnt(1)
    v_bitop3_b32 v4, v227, s43, v4 bitop3:0xbe
    v_bitop3_b32 v4, v225, s43, v4 bitop3:0xbe
    v_dot2_f32_bf16 v36, v224, s95, v36
    v_dot2_f32_bf16 v38, v226, s95, v38
    v_dot2_f32_bf16 v37, v224, s93, v37
    v_dot2_f32_bf16 v39, v226, s93, v39
    s_waitcnt vmcnt(0)
    v_bitop3_b32 v4, v231, s43, v4 bitop3:0xbe
    v_bitop3_b32 v4, v229, s43, v4 bitop3:0xbe
    v_cmp_ne_u32 vcc, 0, v4
    v_dot2_f32_bf16 v36, v228, s95, v36
    v_dot2_f32_bf16 v38, v230, s95, v38
    v_dot2_f32_bf16 v37, v228, s93, v37
    v_dot2_f32_bf16 v39, v230, s93, v39
    s_cbranch_vccnz L_rdp_re
L_rdp_ok:
    v_permlane32_swap_b32 v36, v38
    s_nop 0
    v_permlane32_swap_b32 v37, v39
    v_pk_add_f32 v[36:37], v[36:37], v[38:39]
    s_nop 1
    v_permlane16_swap_b32 v36, v37
    v_add_f32 v36, v36, v37
    s_nop 1
    v_add_f32_dpp v36, v36, v36 row_ror:8 row_mask:0xf bank_mask:0xf bound_ctrl:1
    s_cmp_gt_u32 s94, 1
    v_fmac_f32 v185, v188, v36
    v_mul_f32 v36, v185, v189
    v_mul_f32 v40, v185, v185
    v_mov_b32 v37, v36
    v_cndmask_b32 v40, v185, v40, s[48:49]
    s_nop 0
    v_permlane16_swap_b32 v36, v37
    v_add_f32_dpp v40, v40, v40 quad_perm:[1,0,3,2] row_mask:0xf bank_mask:0xf bound_ctrl:1
    v_cvt_pk_bf16_f32 v38, v36, v37
    v_lshlrev_b32 v4, 16, v38
    v_add_f32_dpp v40, v40, v40 quad_perm:[2,3,0,1] row_mask:0xf bank_mask:0xf bound_ctrl:1
    v_and_b32 v5, 0xffff0000, v38
    v_sub_f32 v36, v36, v4
    v_add_f32_dpp v40, v40, v40 row_half_mirror row_mask:0xf bank_mask:0xf bound_ctrl:1
    v_sub_f32 v37, v37, v5
    v_mov_b32 v41, v40
    v_cvt_pk_bf16_f32 v39, v36, v37
    s_nop 0
    v_permlane16_swap_b32 v41, v40
    v_cndmask_b32 v38, v38, v39, s[50:51]
    v_add_f32 v40, v40, v41
    s_cbranch_scc1 L_yrem
    s_mov_b32 exec_lo, 0xff00ff
    s_mov_b32 exec_hi, 0xff00ff
    buffer_store_dword v38, v192, s[16:19], s11 offen
    s_mov_b64 exec, -1
    v_mov_b32 v41, v40
    s_nop 1
    v_permlane32_swap_b32 v41, v40
    v_add_f32 v40, v40, v41
    s_mov_b64 exec, 0x101
    buffer_store_dword v40, v193, s[16:19], s12 offen
    s_mov_b64 exec, -1
    s_cmp_eq_u32 s55, s54
    s_cbranch_scc0 L_notfin
    s_lshl_b32 s39, s36, 7
    s_add_u32 s39, s39, 1359872
    v_lshlrev_b32 v5, 2, v1
    s_mov_b32 s44, 0
    s_mov_b64 exec, 0xfffffff
L_mfw:
    buffer_load_dword v4, v5, s[16:19], s39 offen sc1
    s_add_u32 s44, s44, 1
    s_cmp_gt_u32 s44, 100000
    s_waitcnt vmcnt(0)
    s_cbranch_scc1 L_mfw_x
    v_cmp_ne_u32 vcc, s43, v4
    s_cbranch_vccnz L_mfw
L_mfw_x:
    s_mov_b64 exec, -1

L_fin:
    buffer_load_dwordx4 v[64:67], v29, s[16:19], s13 offen offset:0 sc1
    buffer_load_dwordx4 v[68:71], v29, s[16:19], s13 offen offset:1024 sc1
    buffer_load_dwordx4 v[72:75], v29, s[16:19], s13 offen offset:2048 sc1
    buffer_load_dwordx4 v[76:79], v29, s[16:19], s13 offen offset:3072 sc1
    buffer_load_dwordx4 v[80:83], v29, s[16:19], s26 offen offset:0 sc1
    buffer_load_dwordx4 v[84:87], v29, s[16:19], s26 offen offset:1024 sc1
    buffer_load_dwordx4 v[88:91], v29, s[16:19], s26 offen offset:2048 sc1
    v_mov_b32 v6, 0
    s_mov_b32 s44, 0
    s_branch L_fnp_m
L_fnp_re:
    s_add_u32 s44, s44, 1
    s_cmp_gt_u32 s44, 100000
    s_cbranch_scc1 L_fnp_ok
    buffer_load_dwordx4 v[64:67], v29, s[16:19], s13 offen offset:0 sc1
    buffer_load_dwordx4 v[68:71], v29, s[16:19], s13 offen offset:1024 sc1
    buffer_load_dwordx4 v[72:75], v29, s[16:19], s13 offen offset:2048 sc1
    buffer_load_dwordx4 v[76:79], v29, s[16:19], s13 offen offset:3072 sc1
    buffer_load_dwordx4 v[80:83], v29, s[16:19], s26 offen offset:0 sc1
    buffer_load_dwordx4 v[84:87], v29, s[16:19], s26 offen offset:1024 sc1
    buffer_load_dwordx4 v[88:91], v29, s[16:19], s26 offen offset:2048 sc1
L_fnp_m:
    s_waitcnt vmcnt(6)
    v_xor_b32 v4, s43, v67
    v_dot2_f32_bf16 v36, v64, s95, 0
    v_dot2_f32_bf16 v38, v66, s95, 0
    v_dot2_f32_bf16 v37, v64, s93, 0
    v_dot2_f32_bf16 v39, v66, s93, 0
    s_waitcnt vmcnt(5)
    v_bitop3_b32 v4, v71, s43, v4 bitop3:0xbe
    v_dot2_f32_bf16 v36, v68, s95, v36
    v_dot2_f32_bf16 v38, v70, s95, v38
    v_dot2_f32_bf16 v37, v68, s93, v37
    v_dot2_f32_bf16 v39, v70, s93, v39
    s_waitcnt vmcnt(4)
    v_bitop3_b32 v4, v75, s43, v4 bitop3:0xbe
    v_dot2_f32_bf16 v36, v72, s95, v36
    v_dot2_f32_bf16 v38, v74, s95, v38
    v_dot2_f32_bf16 v37, v72, s93, v37
    v_dot2_f32_bf16 v39, v74, s93, v39
    s_waitcnt vmcnt(3)
    v_bitop3_b32 v4, v79, s43, v4 bitop3:0xbe
    v_dot2_f32_bf16 v36, v76, s95, v36
    v_dot2_f32_bf16 v38, v78, s95, v38
    v_dot2_f32_bf16 v37, v76, s93, v37
    v_dot2_f32_bf16 v39, v78, s93, v39
    s_waitcnt vmcnt(2)
    v_bitop3_b32 v4, v83, s43, v4 bitop3:0xbe
    v_dot2_f32_bf16 v36, v80, s95, v36
    v_dot2_f32_bf16 v38, v82, s95, v38
    v_dot2_f32_bf16 v37, v80, s93, v37
    v_dot2_f32_bf16 v39, v82, s93, v39
    s_waitcnt vmcnt(1)
    v_bitop3_b32 v4, v87, s43, v4 bitop3:0xbe
    v_dot2_f32_bf16 v36, v84, s95, v36
    v_dot2_f32_bf16 v38, v86, s95, v38
    v_dot2_f32_bf16 v37, v84, s93, v37
    v_dot2_f32_bf16 v39, v86, s93, v39
    s_waitcnt vmcnt(0)
    v_bitop3_b32 v4, v91, s43, v4 bitop3:0xbe
    v_cmp_ne_u32 vcc, 0, v4
    v_dot2_f32_bf16 v36, v88, s95, v36
    v_dot2_f32_bf16 v38, v90, s95, v38
    v_dot2_f32_bf16 v37, v88, s93, v37
    v_dot2_f32_bf16 v39, v90, s93, v39
    s_cbranch_vccnz L_fnp_re
L_fnp_ok:
    v_permlane32_swap_b32 v36, v38
    s_nop 0
    v_permlane32_swap_b32 v37, v39
    v_pk_add_f32 v[36:37], v[36:37], v[38:39]
    s_nop 1
    v_permlane16_swap_b32 v36, v37
    v_add_f32 v36, v36, v37
    s_nop 1
    v_add_f32_dpp v36, v36, v36 row_ror:8 row_mask:0xf bank_mask:0xf bound_ctrl:1
    v_fmac_f32 v185, v190, v36
    v_mov_b32 v37, v185
    s_nop 1
    v_permlane16_swap_b32 v185, v37
    s_mov_b32 exec_lo, 0xff
    s_mov_b32 exec_hi, 0xff
    v_cvt_pk_bf16_f32 v38, v185, v37
    buffer_store_dword v38, v195, s[32:35], s14 offen
L_fin_end:
    s_endpgm

L_c_orem:
    buffer_store_dwordx4 v[36:39], v27, s[16:19], s4 offen sc1
    s_lshl_b32 s39, s36, 9
    s_lshl_b32 s59, s37, 4
    s_add_u32 s39, s39, s59
    s_lshl_b32 s59, s47, 2
    s_add_u32 s39, s39, s59
    s_add_u32 s39, s39, 1363968
    s_waitcnt vmcnt(0)
    s_mov_b64 exec, 1
    v_mov_b32 v4, 0
    v_mov_b32 v5, s43
    buffer_store_dword v5, v4, s[16:19], s39 offen sc1
    s_mov_b64 exec, -1
    s_cmp_lt_u32 s37, 16
    s_cbranch_scc0 L_c_other
    s_barrier
    s_lshl_b32 s39, s36, 9
    s_lshl_b32 s59, s54, 8
    s_add_u32 s39, s39, s59
    s_add_u32 s39, s39, 1363968
    v_lshlrev_b32 v5, 2, v1
    s_mov_b32 s44, 0
    s_mov_b64 exec, -1
L_ofw:
    buffer_load_dword v4, v5, s[16:19], s39 offen sc1
    s_add_u32 s44, s44, 1
    s_cmp_gt_u32 s44, 100000
    s_waitcnt vmcnt(0)
    s_cbranch_scc1 L_ofw_x
    v_cmp_ne_u32 vcc, s43, v4
    s_cbranch_vccnz L_ofw
L_ofw_x:
    s_mov_b64 exec, -1
    s_add_u32 s7, s7, 262144
    s_add_u32 s8, s8, 8192
    buffer_load_dwordx2 v[208:209], v184, s[16:19], s8 offen sc1
    buffer_load_dwordx4 v[216:219], v29, s[16:19], s7 offen offset:0 sc1
    buffer_load_dwordx4 v[220:223], v29, s[16:19], s7 offen offset:1024 sc1
    buffer_load_dwordx4 v[224:227], v29, s[16:19], s7 offen offset:2048 sc1
    buffer_load_dwordx4 v[228:231], v29, s[16:19], s7 offen offset:3072 sc1
    s_waitcnt vmcnt(0)
    s_branch L_t1_w
L_t1rem:
    ds_read_b64_tr_b16 v[64:65], v196 offset:0
    ds_read_b64_tr_b16 v[66:67], v196 offset:4096
    ds_read_b64_tr_b16 v[68:69], v197 offset:0
    ds_read_b64_tr_b16 v[70:71], v197 offset:4096
    ds_read_b64_tr_b16 v[72:73], v198 offset:0
    ds_read_b64_tr_b16 v[74:75], v198 offset:4096
    ds_read_b64_tr_b16 v[76:77], v199 offset:0
    ds_read_b64_tr_b16 v[78:79], v199 offset:4096
    ds_read_b64_tr_b16 v[80:81], v196 offset:8192
    ds_read_b64_tr_b16 v[82:83], v196 offset:12288
    ds_read_b64_tr_b16 v[84:85], v197 offset:8192
    ds_read_b64_tr_b16 v[86:87], v197 offset:12288
    ds_read_b64_tr_b16 v[88:89], v198 offset:8192
    ds_read_b64_tr_b16 v[90:91], v198 offset:12288
    ds_read_b64_tr_b16 v[92:93], v199 offset:8192
    ds_read_b64_tr_b16 v[94:95], v199 offset:12288
    ds_read_b64_tr_b16 v[96:97], v196 offset:16384
    ds_read_b64_tr_b16 v[98:99], v196 offset:20480
    ds_read_b64_tr_b16 v[100:101], v197 offset:16384
    ds_read_b64_tr_b16 v[102:103], v197 offset:20480
    ds_read_b64_tr_b16 v[104:105], v198 offset:16384
    ds_read_b64_tr_b16 v[106:107], v198 offset:20480
    ds_read_b64_tr_b16 v[108:109], v199 offset:16384
    ds_read_b64_tr_b16 v[110:111], v199 offset:20480
    ds_read_b64_tr_b16 v[112:113], v196 offset:24576
    ds_read_b64_tr_b16 v[114:115], v196 offset:28672
    ds_read_b64_tr_b16 v[116:117], v197 offset:24576
    ds_read_b64_tr_b16 v[118:119], v197 offset:28672
    ds_read_b64_tr_b16 v[120:121], v198 offset:24576
    ds_read_b64_tr_b16 v[122:123], v198 offset:28672
    ds_read_b64_tr_b16 v[124:125], v199 offset:24576
    ds_read_b64_tr_b16 v[126:127], v199 offset:28672
    s_waitcnt lgkmcnt(0)
    v_mfma_f32_16x16x32_bf16 v[44:47], v[216:219], v[64:67], 0
    v_mfma_f32_16x16x32_bf16 v[52:55], v[216:219], v[72:75], 0
    v_mfma_f32_16x16x32_bf16 v[48:51], v[216:219], v[68:71], 0
    v_mfma_f32_16x16x32_bf16 v[56:59], v[216:219], v[76:79], 0
    s_branch L_t1p_ok
L_yrem:
    s_add_u32 s11, s11, 81920
    s_add_u32 s12, s12, 81920
    s_mov_b32 exec_lo, 0xff00ff
    s_mov_b32 exec_hi, 0xff00ff
    buffer_store_dword v38, v192, s[16:19], s11 offen sc1
    s_mov_b64 exec, -1
    v_mov_b32 v41, v40
    s_nop 1
    v_permlane32_swap_b32 v41, v40
    v_add_f32 v40, v40, v41
    s_mov_b64 exec, 0x101
    buffer_store_dword v40, v193, s[16:19], s12 offen sc1
    s_lshl_b32 s39, s36, 7
    s_lshl_b32 s59, s15, 2
    s_add_u32 s39, s39, s59
    s_add_u32 s39, s39, 1372160
    s_waitcnt vmcnt(0)
    s_mov_b64 exec, 1
    v_mov_b32 v4, 0
    v_mov_b32 v5, s43
    buffer_store_dword v5, v4, s[16:19], s39 offen sc1
    s_mov_b64 exec, -1
    s_cmp_eq_u32 s55, s54
    s_cbranch_scc0 L_notfin
    s_branch L_fin
L_notfin:
    s_cmp_eq_u32 s2, 4
    s_cbranch_scc0 L_fin_end
    s_cmp_eq_u32 s47, 0
    s_cbranch_scc0 L_fin_end
    s_mov_b64 exec, 1
    v_mov_b32 v6, 0
    buffer_store_dword v205, v6, s[16:19], 0 offen sc1
    s_branch L_fin_end
L_c_qre:
    s_mov_b32 s44, 0
L_c_qre2:
    buffer_load_dwordx4 v[208:211], v31, s[16:19], s39 offen sc1
    buffer_load_dwordx4 v[212:215], v31, s[16:19], s40 offen sc1
    s_add_u32 s44, s44, 1
    s_cmp_ge_u32 s44, 8
    s_waitcnt vmcnt(0)
    s_cbranch_scc1 L_c_qB
    v_xor_b32 v4, s92, v209
    v_bitop3_b32 v4, v211, s92, v4 bitop3:0xbe
    v_bitop3_b32 v4, v213, s92, v4 bitop3:0xbe
    v_bitop3_b32 v4, v215, s92, v4 bitop3:0xbe
    v_cmp_ne_u32 vcc, 0, v4
    s_cbranch_vccnz L_c_qre2
    s_branch L_c_qok
L_c_qB:
    s_add_u32 s39, s39, 262144
    s_add_u32 s40, s40, 262144
L_c_qB2:
    buffer_load_dwordx4 v[208:211], v31, s[16:19], s39 offen sc1
    buffer_load_dwordx4 v[212:215], v31, s[16:19], s40 offen sc1
    s_add_u32 s44, s44, 1
    s_cmp_gt_u32 s44, 100000
    s_waitcnt vmcnt(0)
    s_cbranch_scc1 L_c_qB3
    v_subrev_u32 v36, s43, v209
    v_subrev_u32 v37, s43, v211
    v_subrev_u32 v38, s43, v213
    v_subrev_u32 v39, s43, v215
    v_max3_u32 v4, v36, v37, v38
    v_max_u32 v4, v4, v39
    v_cmp_lt_u32 vcc, 7, v4
    s_cbranch_vccnz L_c_qB2
L_c_qB3:
    v_xor_b32 v4, s92, v209
    v_bitop3_b32 v4, v211, s92, v4 bitop3:0xbe
    v_bitop3_b32 v4, v213, s92, v4 bitop3:0xbe
    v_bitop3_b32 v4, v215, s92, v4 bitop3:0xbe
    v_cmp_ne_u32 vcc, 0, v4
    s_cbranch_vccz L_c_qok
    v_mov_b32 v7, 2
    s_branch L_c_qok
L_c_strem:
    s_add_u32 s5, s5, 8192
    s_add_u32 s4, s4, 262144
    s_cbranch_execz L_c_stdone
    buffer_store_dwordx2 v[60:61], v28, s[16:19], s5 offen sc1
    s_branch L_c_stdone

L_c_other:
    s_sub_u32 s39, s37, 16
    s_cmp_lt_u32 s39, 7
    s_cbranch_scc0 L_fin_end
    s_cmp_gt_u32 s94, 1
    s_cbranch_scc1 L_mrem0
    buffer_load_dwordx4 v[156:159], v184, s[16:19], s7 offen offset:256 sc1
    s_barrier
    s_waitcnt vmcnt(0)
    v_max3_u32 v4, v156, v157, v158
    v_max_u32 v4, v4, v159
    v_cmp_eq_u32 vcc, -1, v4
    s_cbranch_vccnz L_mcp_re
L_mcp_ok:
    v_mov_b32_dpp v128, v156 row_shr:4 row_mask:0xf bank_mask:0xf bound_ctrl:1
    v_mov_b32_dpp v129, v157 row_shr:4 row_mask:0xf bank_mask:0xf bound_ctrl:1
    v_mov_b32_dpp v130, v158 row_shr:4 row_mask:0xf bank_mask:0xf bound_ctrl:1
    v_mov_b32_dpp v131, v159 row_shr:4 row_mask:0xf bank_mask:0xf bound_ctrl:1
    v_mov_b32_dpp v132, v156 quad_perm:[0,1,2,3] row_mask:0xf bank_mask:0xf bound_ctrl:1
    v_mov_b32_dpp v133, v157 quad_perm:[0,1,2,3] row_mask:0xf bank_mask:0xf bound_ctrl:1
    v_mov_b32_dpp v134, v158 quad_perm:[0,1,2,3] row_mask:0xf bank_mask:0xf bound_ctrl:1
    v_mov_b32_dpp v135, v159 quad_perm:[0,1,2,3] row_mask:0xf bank_mask:0xf bound_ctrl:1
    v_mov_b32_dpp v136, v156 row_shl:4 row_mask:0xf bank_mask:0xf bound_ctrl:1
    v_mov_b32_dpp v137, v157 row_shl:4 row_mask:0xf bank_mask:0xf bound_ctrl:1
    v_mov_b32_dpp v138, v158 row_shl:4 row_mask:0xf bank_mask:0xf bound_ctrl:1
    v_mov_b32_dpp v139, v159 row_shl:4 row_mask:0xf bank_mask:0xf bound_ctrl:1
    v_mov_b32_dpp v140, v156 row_shl:8 row_mask:0xf bank_mask:0xf bound_ctrl:1
    v_mov_b32_dpp v141, v157 row_shl:8 row_mask:0xf bank_mask:0xf bound_ctrl:1
    v_mov_b32_dpp v142, v158 row_shl:8 row_mask:0xf bank_mask:0xf bound_ctrl:1
    v_mov_b32_dpp v143, v159 row_shl:8 row_mask:0xf bank_mask:0xf bound_ctrl:1
    v_mov_b32 v169, s43
    v_mov_b32 v171, s43
    v_mov_b32 v200, v189
    v_mov_b32 v201, 0
    v_mov_b32 v208, 0
    v_mov_b32 v209, 0
    v_mov_b32 v210, 0
    v_mov_b32 v211, 0
    v_mov_b32 v212, 0
    v_mov_b32 v213, 0
    v_mov_b32 v214, 0
    v_mov_b32 v215, 0
    v_mov_b32 v216, 0
    v_mov_b32 v217, 0
    v_mov_b32 v218, 0
    v_mov_b32 v219, 0
    v_mov_b32 v220, 0
    v_mov_b32 v221, 0
    v_mov_b32 v222, 0
    v_mov_b32 v223, 0
    v_mov_b32 v224, 0
    v_mov_b32 v225, 0
    v_mov_b32 v226, 0
    v_mov_b32 v227, 0
    v_mov_b32 v228, 0
    v_mov_b32 v229, 0
    v_mov_b32 v230, 0
    v_mov_b32 v231, 0
    v_mov_b32 v232, 0
    v_mov_b32 v233, 0
    v_mov_b32 v234, 0
    v_mov_b32 v235, 0
    v_mov_b32 v236, 0
    v_mov_b32 v237, 0
    v_mov_b32 v238, 0
    v_mov_b32 v239, 0
    v_cmp_gt_u32 s[48:49], 8, v3
    s_cmp_gt_u32 s94, 1
    s_barrier
    ds_read_b64_tr_b16 v[64:65], v190 offset:0
    ds_read_b64_tr_b16 v[66:67], v190 offset:1024
    ds_read_b64_tr_b16 v[80:81], v191 offset:0
    ds_read_b64_tr_b16 v[82:83], v191 offset:1024
    ds_read_b64_tr_b16 v[68:69], v190 offset:2048
    ds_read_b64_tr_b16 v[70:71], v190 offset:3072
    ds_read_b64_tr_b16 v[84:85], v191 offset:2048
    ds_read_b64_tr_b16 v[86:87], v191 offset:3072
    ds_read_b64_tr_b16 v[72:73], v190 offset:4096
    ds_read_b64_tr_b16 v[74:75], v190 offset:5120
    ds_read_b64_tr_b16 v[88:89], v191 offset:4096
    ds_read_b64_tr_b16 v[90:91], v191 offset:5120
    ds_read_b64_tr_b16 v[76:77], v190 offset:6144
    ds_read_b64_tr_b16 v[78:79], v190 offset:7168
    ds_read_b64_tr_b16 v[92:93], v191 offset:6144
    ds_read_b64_tr_b16 v[94:95], v191 offset:7168
    ds_read_b64_tr_b16 v[96:97], v192 offset:0
    ds_read_b64_tr_b16 v[98:99], v192 offset:4096
    ds_read_b64_tr_b16 v[100:101], v193 offset:0
    ds_read_b64_tr_b16 v[102:103], v193 offset:4096
    ds_read_b64_tr_b16 v[104:105], v194 offset:0
    ds_read_b64_tr_b16 v[106:107], v194 offset:4096
    ds_read_b64_tr_b16 v[108:109], v195 offset:0
    ds_read_b64_tr_b16 v[110:111], v195 offset:4096
    ds_read_b64_tr_b16 v[112:113], v196 offset:0
    ds_read_b64_tr_b16 v[114:115], v196 offset:4096
    ds_read_b64_tr_b16 v[116:117], v197 offset:0
    ds_read_b64_tr_b16 v[118:119], v197 offset:4096
    ds_read_b64_tr_b16 v[120:121], v198 offset:0
    ds_read_b64_tr_b16 v[122:123], v198 offset:4096
    ds_read_b64_tr_b16 v[124:125], v199 offset:0
    ds_read_b64_tr_b16 v[126:127], v199 offset:4096
    s_cbranch_scc1 L_mrem
    buffer_load_dwordx4 v[156:159], v184, s[16:19], s7 offen sc1
    buffer_load_dwordx2 v[152:153], v185, s[16:19], s8 offen sc1
    s_mov_b32 s44, 0
    s_branch L_myp_m
L_myp_re:
    s_add_u32 s44, s44, 1
    s_cmp_gt_u32 s44, 100000
    s_cbranch_scc1 L_myp_ok
    buffer_load_dwordx4 v[156:159], v184, s[16:19], s7 offen sc1
    buffer_load_dwordx2 v[152:153], v185, s[16:19], s8 offen sc1
L_myp_m:
    s_waitcnt vmcnt(0)
    v_max3_u32 v4, v156, v157, v158
    v_max3_u32 v4, v4, v159, v152
    v_max_u32 v4, v4, v153
    v_cmp_eq_u32 vcc, -1, v4
    s_cbranch_vccnz L_myp_re
L_myp_ok:
    v_mov_b32_dpp v128, v156 quad_perm:[0,1,2,3] row_mask:0xf bank_mask:0x1 bound_ctrl:1
    v_mov_b32_dpp v129, v157 quad_perm:[0,1,2,3] row_mask:0xf bank_mask:0x1 bound_ctrl:1
    v_mov_b32_dpp v130, v158 quad_perm:[0,1,2,3] row_mask:0xf bank_mask:0x1 bound_ctrl:1
    v_mov_b32_dpp v131, v159 quad_perm:[0,1,2,3] row_mask:0xf bank_mask:0x1 bound_ctrl:1
    s_waitcnt lgkmcnt(0)
    v_mov_b32_dpp v132, v156 row_shl:4 row_mask:0xf bank_mask:0x1 bound_ctrl:1
    v_mov_b32_dpp v133, v157 row_shl:4 row_mask:0xf bank_mask:0x1 bound_ctrl:1
    v_mov_b32_dpp v134, v158 row_shl:4 row_mask:0xf bank_mask:0x1 bound_ctrl:1
    v_mov_b32_dpp v135, v159 row_shl:4 row_mask:0xf bank_mask:0x1 bound_ctrl:1
    v_mfma_f32_16x16x32_bf16 v[144:147], v[64:67], v[128:131], 0
    v_mfma_f32_16x16x32_bf16 v[148:151], v[80:83], v[128:131], 0
    v_mov_b32_dpp v136, v156 row_shl:8 row_mask:0xf bank_mask:0x1 bound_ctrl:1
    v_mov_b32_dpp v137, v157 row_shl:8 row_mask:0xf bank_mask:0x1 bound_ctrl:1
    v_mov_b32_dpp v138, v158 row_shl:8 row_mask:0xf bank_mask:0x1 bound_ctrl:1
    v_mov_b32_dpp v139, v159 row_shl:8 row_mask:0xf bank_mask:0x1 bound_ctrl:1
    v_mfma_f32_16x16x32_bf16 v[144:147], v[68:71], v[132:135], v[144:147]
    v_mfma_f32_16x16x32_bf16 v[148:151], v[84:87], v[132:135], v[148:151]
    v_mov_b32_dpp v140, v156 row_shl:12 row_mask:0xf bank_mask:0x1 bound_ctrl:1
    v_mov_b32_dpp v141, v157 row_shl:12 row_mask:0xf bank_mask:0x1 bound_ctrl:1
    v_mov_b32_dpp v142, v158 row_shl:12 row_mask:0xf bank_mask:0x1 bound_ctrl:1
    v_mov_b32_dpp v143, v159 row_shl:12 row_mask:0xf bank_mask:0x1 bound_ctrl:1
    v_mfma_f32_16x16x32_bf16 v[144:147], v[72:75], v[136:139], v[144:147]
    v_mfma_f32_16x16x32_bf16 v[148:151], v[88:91], v[136:139], v[148:151]
    v_add_f32_dpp v152, v152, v152 row_ror:2 row_mask:0xf bank_mask:0xf bound_ctrl:1
    v_add_f32_dpp v153, v153, v153 row_ror:2 row_mask:0xf bank_mask:0xf bound_ctrl:1
    v_mfma_f32_16x16x32_bf16 v[144:147], v[76:79], v[140:143], v[144:147]
    v_add_f32_dpp v152, v152, v152 row_ror:4 row_mask:0xf bank_mask:0xf bound_ctrl:1
    v_add_f32_dpp v153, v153, v153 row_ror:4 row_mask:0xf bank_mask:0xf bound_ctrl:1
    v_mfma_f32_16x16x32_bf16 v[148:151], v[92:95], v[140:143], v[148:151]
    v_add_f32_dpp v152, v152, v152 row_ror:8 row_mask:0xf bank_mask:0xf bound_ctrl:1
    v_add_f32_dpp v153, v153, v153 row_ror:8 row_mask:0xf bank_mask:0xf bound_ctrl:1
    v_mov_b32 v154, v152
    v_mov_b32 v155, v153
    s_nop 0
    v_permlane16_swap_b32 v154, v152
    v_permlane16_swap_b32 v155, v153
    s_mov_b64 exec, s[48:49]
    ds_write_b128 v186, v[144:147] offset:0
    ds_write_b128 v186, v[148:151] offset:2240
    s_mov_b64 exec, -1
    v_pk_add_f32 v[152:153], v[152:153], v[154:155]
    v_mul_f32 v152, 0x3b000000, v152
    v_mul_f32 v154, 0x3b000000, v153
    v_fma_f32 v154, -v152, v152, v154
    v_max_f32 v154, 0, v154
    v_add_f32 v154, 0x3727c5ac, v154
    v_rsq_f32 v154, v154
    s_waitcnt lgkmcnt(0)
    s_barrier
    ds_read2_b32 v[44:45], v187 offset0:0 offset1:68
    ds_read2_b32 v[46:47], v187 offset0:16 offset1:84
    ds_read2_b32 v[48:49], v187 offset0:32 offset1:100
    ds_read2_b32 v[50:51], v187 offset0:48 offset1:116
    ds_read2_b32 v[52:53], v202 offset0:0 offset1:68
    ds_read2_b32 v[54:55], v202 offset0:16 offset1:84
    ds_read2_b32 v[56:57], v202 offset0:32 offset1:100
    ds_read2_b32 v[58:59], v202 offset0:48 offset1:116
    s_waitcnt lgkmcnt(4)
    v_pk_add_f32 v[44:45], v[44:45], v[46:47]
    v_pk_add_f32 v[48:49], v[48:49], v[50:51]
    v_pk_add_f32 v[44:45], v[44:45], v[48:49]
    v_add_f32 v46, v44, v45
    s_waitcnt lgkmcnt(0)
    v_pk_add_f32 v[52:53], v[52:53], v[54:55]
    v_pk_add_f32 v[56:57], v[56:57], v[58:59]
    v_pk_add_f32 v[52:53], v[52:53], v[56:57]
    v_fma_f32 v46, -v152, v52, v46
    v_fma_f32 v46, v46, v154, v53
    v_mul_f32 v47, 0xbfb8aa3b, v46
    v_exp_f32 v47, v47
    s_nop 0
    v_add_f32 v47, 1.0, v47
    v_rcp_f32 v47, v47
    s_nop 0
    v_mul_f32 v46, v46, v47
    s_nop 1
    v_mov_b32_dpp v47, v46 row_shl:2 row_mask:0xf bank_mask:0xf bound_ctrl:1
    v_cvt_pk_bf16_f32 v48, v46, v47
    v_cndmask_b32 v48, v48, 0, s[52:53]
    s_nop 1
    v_mov_b32_dpp v208, v48 quad_perm:[0,1,2,3] row_mask:0xf bank_mask:0x1 bound_ctrl:1
    v_mov_b32_dpp v209, v48 row_shl:4 row_mask:0xf bank_mask:0x1 bound_ctrl:1
    v_mov_b32_dpp v210, v48 row_shl:8 row_mask:0xf bank_mask:0x1 bound_ctrl:1
    v_mov_b32_dpp v211, v48 row_shl:12 row_mask:0xf bank_mask:0x1 bound_ctrl:1
    v_mov_b32_dpp v212, v48 row_shr:2 row_mask:0xf bank_mask:0x1 bound_ctrl:1
    v_mov_b32_dpp v213, v48 row_shl:2 row_mask:0xf bank_mask:0x1 bound_ctrl:1
    v_mov_b32_dpp v214, v48 row_shl:6 row_mask:0xf bank_mask:0x1 bound_ctrl:1
    v_mov_b32_dpp v215, v48 row_shl:10 row_mask:0xf bank_mask:0x1 bound_ctrl:1
    v_mfma_f32_16x16x32_bf16 v[164:167], v[96:99], v[208:211], 0
    v_mov_b32_dpp v216, v48 row_shr:4 row_mask:0xf bank_mask:0x2 bound_ctrl:1
    v_mov_b32_dpp v217, v48 quad_perm:[0,1,2,3] row_mask:0xf bank_mask:0x2 bound_ctrl:1
    v_mov_b32_dpp v218, v48 row_shl:4 row_mask:0xf bank_mask:0x2 bound_ctrl:1
    v_mov_b32_dpp v219, v48 row_shl:8 row_mask:0xf bank_mask:0x2 bound_ctrl:1
    v_mfma_f32_16x16x32_bf16 v[164:167], v[100:103], v[212:215], v[164:167]
    v_mov_b32_dpp v220, v48 row_shr:6 row_mask:0xf bank_mask:0x2 bound_ctrl:1
    v_mov_b32_dpp v221, v48 row_shr:2 row_mask:0xf bank_mask:0x2 bound_ctrl:1
    v_mov_b32_dpp v222, v48 row_shl:2 row_mask:0xf bank_mask:0x2 bound_ctrl:1
    v_mov_b32_dpp v223, v48 row_shl:6 row_mask:0xf bank_mask:0x2 bound_ctrl:1
    v_mfma_f32_16x16x32_bf16 v[164:167], v[104:107], v[216:219], v[164:167]
    v_mov_b32_dpp v224, v48 row_shr:8 row_mask:0xf bank_mask:0x4 bound_ctrl:1
    v_mov_b32_dpp v225, v48 row_shr:4 row_mask:0xf bank_mask:0x4 bound_ctrl:1
    v_mov_b32_dpp v226, v48 quad_perm:[0,1,2,3] row_mask:0xf bank_mask:0x4 bound_ctrl:1
    v_mov_b32_dpp v227, v48 row_shl:4 row_mask:0xf bank_mask:0x4 bound_ctrl:1
    v_mfma_f32_16x16x32_bf16 v[164:167], v[108:111], v[220:223], v[164:167]
    v_mov_b32_dpp v228, v48 row_shr:10 row_mask:0xf bank_mask:0x4 bound_ctrl:1
    v_mov_b32_dpp v229, v48 row_shr:6 row_mask:0xf bank_mask:0x4 bound_ctrl:1
    v_mov_b32_dpp v230, v48 row_shr:2 row_mask:0xf bank_mask:0x4 bound_ctrl:1
    v_mov_b32_dpp v231, v48 row_shl:2 row_mask:0xf bank_mask:0x4 bound_ctrl:1
    v_mfma_f32_16x16x32_bf16 v[164:167], v[112:115], v[224:227], v[164:167]
    v_mov_b32_dpp v232, v48 row_shr:12 row_mask:0xf bank_mask:0x8 bound_ctrl:1
    v_mov_b32_dpp v233, v48 row_shr:8 row_mask:0xf bank_mask:0x8 bound_ctrl:1
    v_mov_b32_dpp v234, v48 row_shr:4 row_mask:0xf bank_mask:0x8 bound_ctrl:1
    v_mov_b32_dpp v235, v48 quad_perm:[0,1,2,3] row_mask:0xf bank_mask:0x8 bound_ctrl:1
    v_mfma_f32_16x16x32_bf16 v[164:167], v[116:119], v[228:231], v[164:167]
    v_mov_b32_dpp v236, v48 row_shr:14 row_mask:0xf bank_mask:0x8 bound_ctrl:1
    v_mov_b32_dpp v237, v48 row_shr:10 row_mask:0xf bank_mask:0x8 bound_ctrl:1
    v_mov_b32_dpp v238, v48 row_shr:6 row_mask:0xf bank_mask:0x8 bound_ctrl:1
    v_mov_b32_dpp v239, v48 row_shr:2 row_mask:0xf bank_mask:0x8 bound_ctrl:1
    v_mfma_f32_16x16x32_bf16 v[164:167], v[120:123], v[232:235], v[164:167]
    s_nop 0
    v_mfma_f32_16x16x32_bf16 v[164:167], v[124:127], v[236:239], v[164:167]
    s_nop 7
    v_cvt_pk_bf16_f32 v168, v164, v165
    v_cvt_pk_bf16_f32 v170, v166, v167
    buffer_store_dwordx4 v[168:171], v200, s[16:19], s10 offen sc1
    s_mov_b64 exec, 1
    buffer_store_dword v169, v201, s[16:19], s11 offen
    s_branch L_fin_end
L_mcp_re:
    s_mov_b32 s44, 0
L_mcp_re2:
    buffer_load_dwordx4 v[156:159], v184, s[16:19], s7 offen offset:256 sc1
    s_add_u32 s44, s44, 1
    s_cmp_gt_u32 s44, 100000
    s_waitcnt vmcnt(0)
    s_cbranch_scc1 L_mcp_ok
    v_max3_u32 v4, v156, v157, v158
    v_max_u32 v4, v4, v159
    v_cmp_eq_u32 vcc, -1, v4
    s_cbranch_vccnz L_mcp_re2
    s_branch L_mcp_ok
L_mrem0:
    s_barrier
    s_add_u32 s7, s7, 81920
    s_add_u32 s8, s8, 81920
    s_lshl_b32 s25, s36, 7
    s_add_u32 s25, s25, 1368064
    v_lshlrev_b32 v5, 2, v1
    s_mov_b32 s44, 0
    s_mov_b64 exec, 0xffff
L_cfw:
    buffer_load_dword v4, v5, s[16:19], s25 offen sc1
    s_add_u32 s44, s44, 1
    s_cmp_gt_u32 s44, 100000
    s_waitcnt vmcnt(0)
    s_cbranch_scc1 L_cfw_x
    v_cmp_ne_u32 vcc, s43, v4
    s_cbranch_vccnz L_cfw
L_cfw_x:
    s_mov_b64 exec, -1
    buffer_load_dwordx4 v[156:159], v184, s[16:19], s7 offen offset:256 sc1
    s_waitcnt vmcnt(0)
    s_branch L_mcp_ok
L_mrem:
    s_add_u32 s25, s25, 4096
    s_mov_b32 s44, 0
    s_mov_b32 exec_lo, 0xffffffff
    s_mov_b32 exec_hi, 0x0
L_yfw:
    buffer_load_dword v4, v5, s[16:19], s25 offen sc1
    s_add_u32 s44, s44, 1
    s_cmp_gt_u32 s44, 100000
    s_waitcnt vmcnt(0)
    s_cbranch_scc1 L_yfw_x
    v_cmp_ne_u32 vcc, s43, v4
    s_cbranch_vccnz L_yfw
L_yfw_x:
    s_mov_b64 exec, -1
    buffer_load_dwordx4 v[156:159], v184, s[16:19], s7 offen sc1
    buffer_load_dwordx2 v[152:153], v185, s[16:19], s8 offen sc1
    s_waitcnt vmcnt(0)
    s_branch L_myp_ok
L_end:
    s_endpgm
L_code_end:
.section .rodata,"a"
.p2align 6
.amdhsa_kernel adaLN_cond__sliding_block_cached__dense_activation_silu__decode_kernel
.amdhsa_next_free_vgpr 240
.amdhsa_next_free_sgpr 96
.amdhsa_accum_offset 240
.amdhsa_group_segment_fixed_size 0
.amdhsa_kernarg_size 104
.amdhsa_user_sgpr_count 2
.amdhsa_user_sgpr_kernarg_segment_ptr 1
.amdhsa_system_sgpr_workgroup_id_x 1
.amdhsa_float_denorm_mode_32 3
.end_amdhsa_kernel
```
